```python
import torch

def _softmax(x, axis=-1):
    return torch.softmax(x, dim=axis)
def _gelu(x):
    return torch.nn.functional.gelu(x, approximate="tanh")
def _silu(x):
    return torch.nn.functional.silu(x)
def _sigmoid(x):
    return torch.sigmoid(x)
def _layernorm(x, axis=-1, eps=1e-5):
    m = x.mean(dim=axis, keepdim=True)
    v = x.var(dim=axis, keepdim=True, unbiased=False)
    return (x - m) / torch.sqrt(v + eps)
def _scatter_add(tgt, idx, src, axis=0):
    return tgt.clone().index_add_(axis, idx, src)
def _segment_sum(src, seg, n):
    out = torch.zeros((n,) + src.shape[1:], dtype=src.dtype)
    return out.index_add_(0, seg, src)
def _pad(x, pw):
    flat = tuple(v for pair in reversed(pw) for v in pair)
    return torch.nn.functional.pad(x, flat)

kernel_name = 'standalone__gqa_block_cached__near_ridge'

def setup_inputs():

    _w = (lambda a: (lambda t: t.to(torch.bfloat16) if t.is_floating_point() else t)(torch.as_tensor(a)))
    B, Sq, D = 16, 80, 576
    Hq, Hkv, Sk, Dh = 32, 16, 1024, 128
    assert Hq % Hkv == 0, (Hq, Hkv)
    return {
        "x": _w((lambda *s: torch.randn(*s, dtype=torch.bfloat16) * 0.8)(B, Sq, D)),
        "k_cache": _w((lambda *s: torch.randn(*s, dtype=torch.bfloat16) * 0.8)(B, Hkv, Sk, Dh)),
        "v_cache": _w((lambda *s: torch.randn(*s, dtype=torch.bfloat16) * 0.05)(B, Hkv, Sk, Dh)),
        "wq": _w((lambda *s: torch.randn(*s, dtype=torch.bfloat16) * 0.8)(D, Hq * Dh) * (D ** -0.5)),
        "wo": _w((lambda *s: torch.randn(*s, dtype=torch.bfloat16) * 0.05)(Hq * Dh, D) * ((Hq * Dh) ** -0.5)),
    }

def reference(x, k_cache, v_cache, wq, wo):
    B, Sq, D = x.shape
    Hq, Dh = 32, 128
    Hkv = k_cache.shape[1]
    rep = Hq // Hkv
    q = (lambda x, *d: x.permute(*d))((x @ wq).reshape(B, Sq, Hq, Dh), 0, 2, 1, 3)
    k = (lambda x, n, axis: torch.repeat_interleave(x, n, dim=axis))(k_cache, rep, axis=1)
    v = (lambda x, n, axis: torch.repeat_interleave(x, n, dim=axis))(v_cache, rep, axis=1)
    scores = torch.einsum("bhqd,bhkd->bhqk", q, k) * (Dh ** -0.5)
    p = _softmax(scores, axis=-1)
    o = torch.einsum("bhqk,bhkd->bhqd", p, v)
    return (lambda x, *d: x.permute(*d))(o, 0, 2, 1, 3).reshape(B, Sq, Hq * Dh) @ wo
```

```asm
; @launch grid=(256,1,1) block=(512,1,1) lds=163840
.amdgcn_target "amdgcn-amd-amdhsa--gfx950"
.text
.globl standalone__gqa_block_cached__near_ridge_kernel
.p2align 8
.type standalone__gqa_block_cached__near_ridge_kernel,@function
standalone__gqa_block_cached__near_ridge_kernel:
    s_load_dwordx16 s[64:79], s[0:1], 0
    s_cmp_ge_u32 s2, 256
    s_cbranch_scc1 L_end
    s_getpc_b64 s[4:5]
L_pc:
    s_bfe_u32 s6, s2, 0x40003
    s_lshl_b32 s6, s6, 11
    v_lshlrev_b32 v2, 7, v0
    v_add_u32 v2, s6, v2
    v_min_u32 v2, L_code_end-L_pc-4, v2
    v_lshrrev_b32 v1, 6, v0
    v_cmp_gt_u32 vcc, 16, v0
    v_and_b32 v216, 63, v0
    v_readfirstlane_b32 s32, v1
    s_and_saveexec_b64 s[6:7], vcc
    s_cbranch_execz L_nowarm
    global_load_dword v229, v2, s[4:5]
L_nowarm:
    s_mov_b64 exec, s[6:7]
    s_and_b32 s34, s2, 3
    s_lshl_b32 s34, s34, 2
    s_bfe_u32 s38, s2, 0x20003
    s_or_b32 s34, s34, s38
    s_lshr_b32 s39, s2, 5
    s_and_b32 s33, s2, 4
    s_lshl_b32 s33, s33, 1
    s_or_b32 s33, s33, s39
    s_lshl_b32 s38, s38, 1
    s_add_u32 s57, s39, s38
    s_cmp_ge_u32 s57, 9
    s_cselect_b32 s38, 9, 0
    s_sub_u32 s57, s57, s38
    v_lshrrev_b32 v230, 5, v216
    v_and_b32 v233, 31, v216
    v_lshlrev_b32 v233, 4, v233
    v_lshlrev_b32 v234, 5, v230
    v_xor_b32 v233, v233, v234
    s_and_b32 s38, s32, 2
    s_lshl_b32 s38, s38, 6
    v_xor_b32 v233, s38, v233
    v_lshl_add_u32 v253, v230, 13, v233
    v_xor_b32 v254, 64, v253
    v_add_u32 v254, 16384, v254
    v_lshrrev_b32 v233, 4, v216
    v_and_b32 v234, 7, v216
    v_xor_b32 v233, v233, v234
    v_lshrrev_b32 v234, 3, v216
    v_mul_u32_u24 v234, 1152, v234
    v_lshl_add_u32 v255, v233, 4, v234
    s_and_b32 s38, s32, 1
    s_lshl_b32 s38, s38, 6
    v_xor_b32 v255, s38, v255
    s_lshl_b32 s42, s57, 19
    s_lshl_b32 s55, s32, 15
    s_add_u32 s42, s42, s55
    s_lshl_b32 s43, s32, 11
    s_lshl_b32 s54, s57, 7
    s_mul_i32 s45, s32, 9216
    s_add_u32 s54, s54, s45
    s_lshl_b32 s44, s32, 10
    s_mov_b32 s18, 92160
    s_mov_b32 s19, 0x20000
    s_mov_b32 s22, 4710912
    s_mov_b32 s23, 0x20000
    s_mul_i32 s38, s33, 92160
    s_lshl_b32 s40, s34, 9
    s_waitcnt lgkmcnt(0)
    s_add_u32 s16, s64, s38
    s_addc_u32 s17, s65, 0
    s_add_u32 s20, s70, s40
    s_addc_u32 s21, s71, 0
    s_cmp_ge_u32 s32, 2
    s_cbranch_scc1 L_x0
    s_add_u32 m0, s44, 142336
    s_add_u32 s39, s54, 73728
    buffer_load_dwordx4 v255, s[16:19], s39 offen lds
L_x0:
    s_add_u32 m0, s44, 134144
    s_nop 0
    buffer_load_dwordx4 v255, s[16:19], s54 offen lds
    s_add_u32 m0, s43, 101376
    s_nop 0
    buffer_load_dwordx4 v253, s[20:23], s42 offen lds
    s_add_u32 m0, s43, 102400
    s_nop 0
    buffer_load_dwordx4 v254, s[20:23], s42 offen lds
    s_and_b32 s35, s32, 3
    s_lshl_b32 s38, s33, 7
    s_add_u32 s38, s38, 33619968
    s_load_dword s46, s[78:79], s38
    s_lshl_b32 s41, s33, 4
    s_add_u32 s41, s41, s34
    s_lshl_b32 s40, s41, 18
    s_add_u32 s8, s66, s40
    s_addc_u32 s9, s67, 0
    s_mov_b32 s10, 262144
    s_mov_b32 s11, 0x20000
    s_add_u32 s12, s68, s40
    s_addc_u32 s13, s69, 0
    s_mov_b32 s14, 262144
    s_mov_b32 s15, 0x20000
    s_and_b32 s40, s34, 14
    s_mul_i32 s40, s40, 294912
    s_add_u32 s24, s72, s40
    s_addc_u32 s25, s73, 0
    s_mov_b32 s26, 589824
    s_mov_b32 s27, 0x20000
    s_mul_i32 s40, s41, 98304
    s_add_u32 s28, s78, s40
    s_addc_u32 s29, s79, 0
    s_mov_b32 s30, 98304
    s_mov_b32 s31, 0x20000
    v_lshlrev_b32 v227, 4, v216
    s_mov_b32 s61, 0
    s_mul_i32 s60, s32, 1056
    v_add_u32 v214, 262144, v253
    v_add_u32 v215, 262144, v254
    s_mov_b32 s47, 100
    s_and_b32 s39, s33, 3
    s_cmp_eq_u32 s39, 1
    s_cselect_b32 s47, 2, s47
    s_cmp_eq_u32 s39, 2
    s_cselect_b32 s47, 4, s47
    s_cmp_eq_u32 s39, 3
    s_cselect_b32 s47, 8, s47
    v_lshrrev_b32 v235, 4, v216
    v_bfe_u32 v231, v216, 2, 2
    v_lshl_add_u32 v233, v235, 3, v231
    v_lshlrev_b32 v233, 9, v233
    v_and_b32 v234, 31, v216
    v_lshl_add_u32 v233, v234, 3, v233
    s_lshl_b32 s38, s32, 6
    v_xor_b32 v233, s38, v233
    v_add_u32 v148, 84992, v233
    v_xor_b32 v233, 32, v233
    v_add_u32 v149, 84992, v233
    v_and_b32 v233, 15, v216
    v_lshrrev_b32 v234, 1, v233
    v_xor_b32 v234, v234, v235
    v_lshlrev_b32 v234, 4, v234
    v_lshl_add_u32 v234, v233, 7, v234
    v_add_u32 v150, 134144, v234
    v_xor_b32 v234, 64, v234
    v_add_u32 v151, 134144, v234
    s_add_u32 m0, s43, 117760
    s_nop 0
    buffer_load_dwordx4 v214, s[20:23], s42 offen lds
    v_mov_b32 v0, 0
    v_mov_b32 v1, 0
    v_mov_b32 v2, 0
    v_mov_b32 v3, 0
    v_mov_b32 v4, 0
    v_mov_b32 v5, 0
    v_mov_b32 v6, 0
    v_mov_b32 v7, 0
    v_mov_b32 v8, 0
    v_mov_b32 v9, 0
    v_mov_b32 v10, 0
    v_mov_b32 v11, 0
    v_mov_b32 v12, 0
    v_mov_b32 v13, 0
    v_mov_b32 v14, 0
    v_mov_b32 v15, 0
    v_mov_b32 v16, 0
    v_mov_b32 v17, 0
    v_mov_b32 v18, 0
    v_mov_b32 v19, 0
    v_mov_b32 v20, 0
    v_mov_b32 v21, 0
    v_mov_b32 v22, 0
    v_mov_b32 v23, 0
    v_mov_b32 v24, 0
    v_mov_b32 v25, 0
    v_mov_b32 v26, 0
    v_mov_b32 v27, 0
    v_mov_b32 v28, 0
    v_mov_b32 v29, 0
    v_mov_b32 v30, 0
    v_mov_b32 v31, 0
    v_mov_b32 v32, 0
    v_mov_b32 v33, 0
    v_mov_b32 v34, 0
    v_mov_b32 v35, 0
    v_mov_b32 v36, 0
    v_mov_b32 v37, 0
    v_mov_b32 v38, 0
    v_mov_b32 v39, 0
    v_mov_b32 v40, 0
    v_mov_b32 v41, 0
    v_mov_b32 v42, 0
    v_mov_b32 v43, 0
    v_mov_b32 v44, 0
    v_mov_b32 v45, 0
    v_mov_b32 v46, 0
    v_mov_b32 v47, 0
    v_mov_b32 v48, 0
    v_mov_b32 v49, 0
    v_mov_b32 v50, 0
    v_mov_b32 v51, 0
    v_mov_b32 v52, 0
    v_mov_b32 v53, 0
    v_mov_b32 v54, 0
    v_mov_b32 v55, 0
    v_mov_b32 v56, 0
    v_mov_b32 v57, 0
    v_mov_b32 v58, 0
    v_mov_b32 v59, 0
    v_mov_b32 v60, 0
    v_mov_b32 v61, 0
    v_mov_b32 v62, 0
    v_mov_b32 v63, 0
    v_mov_b32 v224, 0
    v_mov_b32 v225, 0
    v_mov_b32 v104, 0
    v_mov_b32 v105, 0
    v_bfe_u32 v233, v216, 2, 3
    v_mul_u32_u24 v233, 1056, v233
    v_lshl_add_u32 v233, v230, 8, v233
    v_and_b32 v232, 3, v216
    v_lshl_add_u32 v218, v232, 3, v233
    v_and_b32 v234, 7, v216
    v_mul_u32_u24 v233, 1056, v234
    v_bfe_u32 v231, v216, 3, 1
    v_lshl_add_u32 v233, v231, 8, v233
    v_lshrrev_b32 v235, 4, v216
    v_lshl_add_u32 v217, v235, 4, v233
    v_lshlrev_b32 v233, 1, v235
    v_xor_b32 v233, v233, v234
    v_lshrrev_b32 v234, 3, v216
    v_mul_u32_u24 v234, 1152, v234
    v_lshl_add_u32 v228, v233, 4, v234
    s_and_b32 s38, s34, 1
    s_mul_i32 s39, s38, 294912
    s_sub_u32 s40, 294912, s39
    s_mul_i32 s100, s35, 9216
    s_lshl_b32 s3, s100, 1
    s_mul_i32 s101, s38, 640
    s_add_u32 s100, s100, s101
    s_lshl_b32 s101, s38, 6
    s_add_u32 s3, s3, s101
    s_add_u32 s3, s3, 512
    s_add_u32 s52, s100, s39
    s_add_u32 s100, s100, s40
    s_add_u32 s101, s3, s39
    s_add_u32 s3, s3, s40
    v_and_b32 v233, 1, v235
    v_lshlrev_b32 v233, 1, v233
    v_xor_b32 v233, v233, v232
    v_lshrrev_b32 v234, 2, v216
    v_mul_u32_u24 v234, 1152, v234
    v_lshl_add_u32 v240, v233, 4, v234
    s_mov_b32 s50, 0x3e0293ee
    s_mov_b32 s51, s50
    s_mov_b32 s53, 0x53800000
    s_and_b32 s38, s35, 1
    s_mul_i32 s39, s38, 8448
    v_add_u32 v242, s39, v217
    s_sub_u32 s39, 25344, s39
    s_xor_b32 s38, s35, 0
    s_lshl_b32 s38, s38, 6
    s_add_u32 s38, s38, s39
    v_add_u32 v244, s38, v218
    s_xor_b32 s38, s35, 1
    s_lshl_b32 s38, s38, 6
    s_add_u32 s38, s38, s39
    v_add_u32 v245, s38, v218
    s_xor_b32 s38, s35, 2
    s_lshl_b32 s38, s38, 6
    s_add_u32 s38, s38, s39
    v_add_u32 v246, s38, v218
    s_xor_b32 s38, s35, 3
    s_lshl_b32 s38, s38, 6
    s_add_u32 s38, s38, s39
    v_add_u32 v247, s38, v218
    v_lshlrev_b32 v232, 3, v232
    v_lshrrev_b32 v234, 2, v216
    v_lshl_add_u32 v232, v234, 7, v232
    v_bfe_u32 v234, v216, 3, 2
    v_lshl_add_u32 v232, v234, 5, v232
    v_and_b32 v233, 15, v216
    v_xor_b32 v234, v233, v230
    s_lshl_b32 s38, s35, 2
    v_xor_b32 v234, s38, v234
    v_lshlrev_b32 v234, 4, v234
    v_lshl_add_u32 v234, v233, 8, v234
    v_and_b32 v231, 1, v235
    v_lshl_add_u32 v234, v231, 3, v234
    v_xor_b32 v231, 32, v234
    s_lshr_b32 s38, s32, 2
    s_lshl_b32 s39, s38, 14
    s_add_u32 s39, s39, 101376
    s_lshl_b32 s38, s38, 12
    s_add_u32 s38, s38, 144384
    v_add_u32 v248, s39, v234
    v_add_u32 v249, s39, v231
    v_add_u32 v250, s38, v234
    v_add_u32 v251, s38, v231
    v_xor_b32 v234, v233, v235
    v_lshlrev_b32 v234, 4, v234
    v_lshl_add_u32 v234, v233, 8, v234
    s_lshl_b32 s38, s32, 13
    s_add_u32 s38, s38, 101376
    s_cmp_ge_u32 s32, 4
    s_cselect_b32 s38, 144384, s38
    v_add_u32 v234, s38, v234
    v_xor_b32 v180, 0, v234
    v_xor_b32 v181, 64, v234
    v_xor_b32 v182, 128, v234
    v_xor_b32 v183, 192, v234
    v_add_u32 v252, 73728, v227
    s_cbranch_scc1 L_lc_h
    s_lshr_b32 s38, s32, 1
    s_mul_i32 s38, s38, 20
    s_and_b32 s39, s32, 1
    s_lshl_b32 s39, s39, 1
    s_add_u32 s38, s38, s39
    s_branch L_lc_d
L_lc_h:
    s_mul_i32 s38, s35, 5
    s_add_u32 s38, s38, 4
L_lc_d:
    s_lshl_b32 s38, s38, 10
    v_add_u32 v241, s38, v252
    s_lshl_b32 s38, s35, 5
    v_xor_b32 v236, s38, v232
    v_add_u32 v237, 36864, v236
    v_add_u32 v238, 126976, v236
    v_add_u32 v219, 155392, v217
    s_lshl_b32 s38, s33, 12
    s_add_u32 s38, s38, 33554432
    s_add_u32 s4, s78, s38
    s_addc_u32 s5, s79, 0
    s_mov_b32 s6, 4096
    s_mov_b32 s7, 0x20000
    s_cmp_lg_u32 s32, 0
    s_cbranch_scc1 L_lc_nz
    v_lshlrev_b32 v234, 2, v216
    s_lshl_b32 s38, s34, 8
    buffer_load_dword v229, v234, s[4:7], s38 offen sc1
L_lc_nz:
    s_waitcnt lgkmcnt(0)
    s_mul_i32 s46, s46, 0x9e3779b1
    s_add_u32 s46, s46, 0x7f4a7c15
    s_add_u32 m0, s43, 118784
    s_nop 0
    buffer_load_dwordx4 v215, s[20:23], s42 offen lds
    s_add_u32 s57, s57, 1
    s_cmp_eq_u32 s57, 9
    s_cselect_b32 s57, 0, s57
    s_lshl_b32 s42, s57, 19
    s_lshl_b32 s54, s57, 7
    s_add_u32 s42, s42, s55
    s_add_u32 s54, s54, s45
    s_cmp_ge_u32 s32, 2
    s_cbranch_scc1 L_x00
    s_add_u32 m0, s44, 152576
    s_add_u32 s39, s54, 73728
    buffer_load_dwordx4 v255, s[16:19], s39 offen lds
L_x00:
    s_add_u32 m0, s44, 144384
    s_nop 0
    buffer_load_dwordx4 v255, s[16:19], s54 offen lds
    s_add_u32 m0, s43, 84992
    s_nop 0
    buffer_load_dwordx4 v253, s[20:23], s42 offen lds
    s_add_u32 m0, s43, 86016
    s_nop 0
    buffer_load_dwordx4 v254, s[20:23], s42 offen lds
    s_cmp_lg_u32 s47, 100
    s_cbranch_scc1 L_p_noA
    s_add_u32 m0, s60, 155392
    s_add_u32 s38, s44, 0
    buffer_load_dwordx4 v227, s[8:11], s38 offen nt lds
    s_add_u32 m0, s60, 0
    s_add_u32 s38, s44, 8192
    buffer_load_dwordx4 v227, s[8:11], s38 offen nt lds
    s_add_u32 m0, s60, 16896
    s_add_u32 s38, s44, 0
    buffer_load_dwordx4 v227, s[12:15], s38 offen nt lds
    s_add_u32 m0, s60, 8448
    s_add_u32 s38, s44, 16384
    buffer_load_dwordx4 v227, s[8:11], s38 offen nt lds
    s_add_u32 m0, s60, 25344
    s_add_u32 s38, s44, 8192
    buffer_load_dwordx4 v227, s[12:15], s38 offen nt lds
    s_add_u32 m0, s60, 33792
    s_add_u32 s38, s44, 24576
    buffer_load_dwordx4 v227, s[8:11], s38 offen nt lds
    s_add_u32 m0, s60, 50688
    s_add_u32 s38, s44, 16384
    buffer_load_dwordx4 v227, s[12:15], s38 offen nt lds
    s_add_u32 m0, s60, 42240
    s_add_u32 s38, s44, 32768
    buffer_load_dwordx4 v227, s[8:11], s38 offen nt lds
    s_add_u32 m0, s60, 59136
    s_add_u32 s38, s44, 24576
    buffer_load_dwordx4 v227, s[12:15], s38 offen nt lds
L_p_noA:
    s_cmp_lg_u32 s47, 100
    s_cbranch_scc1 L_p_w
    s_waitcnt vmcnt(14)
    s_branch L_p_w2
L_p_w:
    s_waitcnt vmcnt(5)
L_p_w2:
    s_cmp_ge_u32 s32, 4
    s_cbranch_scc1 L_p_y
    s_barrier
    ds_read_b128 v[160:163], v150 offset:0
    ds_read_b128 v[164:167], v150 offset:2048
    ds_read_b128 v[168:171], v150 offset:4096
    ds_read_b128 v[172:175], v150 offset:6144
    ds_read_b128 v[176:179], v150 offset:8192
    ds_read_b64_tr_b16 v[152:153], v148 offset:16384
    ds_read_b64_tr_b16 v[154:155], v148 offset:18432
    ds_read_b64_tr_b16 v[156:157], v149 offset:16384
    ds_read_b64_tr_b16 v[158:159], v149 offset:18432
    s_waitcnt vmcnt(3) lgkmcnt(0)
    s_barrier
    s_add_u32 m0, s43, 101376
    s_nop 0
    buffer_load_dwordx4 v214, s[20:23], s42 offen lds
    s_add_u32 m0, s43, 102400
    s_nop 0
    buffer_load_dwordx4 v215, s[20:23], s42 offen lds
    v_mfma_f32_16x16x32_bf16 v[108:111], v[152:155], v[160:163], 0
    ds_read_b128 v[192:195], v151 offset:0
    ds_read_b128 v[196:199], v151 offset:2048
    v_mfma_f32_16x16x32_bf16 v[112:115], v[152:155], v[164:167], 0
    ds_read_b128 v[200:203], v151 offset:4096
    ds_read_b128 v[204:207], v151 offset:6144
    v_mfma_f32_16x16x32_bf16 v[116:119], v[152:155], v[168:171], 0
    ds_read_b128 v[208:211], v151 offset:8192
    ds_read_b64_tr_b16 v[184:185], v148 offset:32768
    v_mfma_f32_16x16x32_bf16 v[120:123], v[152:155], v[172:175], 0
    ds_read_b64_tr_b16 v[186:187], v148 offset:34816
    ds_read_b64_tr_b16 v[188:189], v149 offset:32768
    v_mfma_f32_16x16x32_bf16 v[124:127], v[152:155], v[176:179], 0
    ds_read_b64_tr_b16 v[190:191], v149 offset:34816
    v_mfma_f32_16x16x32_bf16 v[128:131], v[156:159], v[160:163], 0
    s_add_u32 s57, s57, 1
    s_cmp_eq_u32 s57, 9
    v_mfma_f32_16x16x32_bf16 v[132:135], v[156:159], v[164:167], 0
    s_cselect_b32 s57, 0, s57
    s_lshl_b32 s42, s57, 19
    v_mfma_f32_16x16x32_bf16 v[136:139], v[156:159], v[168:171], 0
    s_lshl_b32 s54, s57, 7
    s_add_u32 s42, s42, s55
    v_mfma_f32_16x16x32_bf16 v[140:143], v[156:159], v[172:175], 0
    s_add_u32 s54, s54, s45
    v_mfma_f32_16x16x32_bf16 v[144:147], v[156:159], v[176:179], 0
    s_waitcnt vmcnt(2) lgkmcnt(0)
    s_barrier
    s_cmp_ge_u32 s32, 2
    s_cbranch_scc1 L_xx2
    s_add_u32 m0, s44, 142336
    s_add_u32 s39, s54, 73728
    buffer_load_dwordx4 v255, s[16:19], s39 offen lds
L_xx2:
    s_add_u32 m0, s44, 134144
    s_nop 0
    buffer_load_dwordx4 v255, s[16:19], s54 offen lds
    s_add_u32 m0, s43, 117760
    s_nop 0
    buffer_load_dwordx4 v253, s[20:23], s42 offen lds
    s_add_u32 m0, s43, 118784
    s_nop 0
    buffer_load_dwordx4 v254, s[20:23], s42 offen lds
    v_mfma_f32_16x16x32_bf16 v[108:111], v[184:187], v[192:195], v[108:111]
    ds_read_b128 v[160:163], v150 offset:10240
    ds_read_b128 v[164:167], v150 offset:12288
    v_mfma_f32_16x16x32_bf16 v[112:115], v[184:187], v[196:199], v[112:115]
    ds_read_b128 v[168:171], v150 offset:14336
    ds_read_b128 v[172:175], v150 offset:16384
    v_mfma_f32_16x16x32_bf16 v[116:119], v[184:187], v[200:203], v[116:119]
    ds_read_b128 v[176:179], v150 offset:18432
    ds_read_b64_tr_b16 v[152:153], v148 offset:0
    v_mfma_f32_16x16x32_bf16 v[120:123], v[184:187], v[204:207], v[120:123]
    ds_read_b64_tr_b16 v[154:155], v148 offset:2048
    ds_read_b64_tr_b16 v[156:157], v149 offset:0
    v_mfma_f32_16x16x32_bf16 v[124:127], v[184:187], v[208:211], v[124:127]
    ds_read_b64_tr_b16 v[158:159], v149 offset:2048
    v_mfma_f32_16x16x32_bf16 v[128:131], v[188:191], v[192:195], v[128:131]
    v_mfma_f32_16x16x32_bf16 v[132:135], v[188:191], v[196:199], v[132:135]
    v_mfma_f32_16x16x32_bf16 v[136:139], v[188:191], v[200:203], v[136:139]
    v_mfma_f32_16x16x32_bf16 v[140:143], v[188:191], v[204:207], v[140:143]
    v_mfma_f32_16x16x32_bf16 v[144:147], v[188:191], v[208:211], v[144:147]
    s_waitcnt vmcnt(3) lgkmcnt(0)
    s_barrier
    s_add_u32 m0, s43, 84992
    s_nop 0
    buffer_load_dwordx4 v214, s[20:23], s42 offen lds
    s_add_u32 m0, s43, 86016
    s_nop 0
    buffer_load_dwordx4 v215, s[20:23], s42 offen lds
    v_mfma_f32_16x16x32_bf16 v[108:111], v[152:155], v[160:163], v[108:111]
    ds_read_b128 v[192:195], v151 offset:10240
    ds_read_b128 v[196:199], v151 offset:12288
    v_mfma_f32_16x16x32_bf16 v[112:115], v[152:155], v[164:167], v[112:115]
    ds_read_b128 v[200:203], v151 offset:14336
    ds_read_b128 v[204:207], v151 offset:16384
    v_mfma_f32_16x16x32_bf16 v[116:119], v[152:155], v[168:171], v[116:119]
    ds_read_b128 v[208:211], v151 offset:18432
    ds_read_b64_tr_b16 v[184:185], v148 offset:16384
    v_mfma_f32_16x16x32_bf16 v[120:123], v[152:155], v[172:175], v[120:123]
    ds_read_b64_tr_b16 v[186:187], v148 offset:18432
    ds_read_b64_tr_b16 v[188:189], v149 offset:16384
    v_mfma_f32_16x16x32_bf16 v[124:127], v[152:155], v[176:179], v[124:127]
    ds_read_b64_tr_b16 v[190:191], v149 offset:18432
    v_mfma_f32_16x16x32_bf16 v[128:131], v[156:159], v[160:163], v[128:131]
    s_add_u32 s57, s57, 1
    s_cmp_eq_u32 s57, 9
    v_mfma_f32_16x16x32_bf16 v[132:135], v[156:159], v[164:167], v[132:135]
    s_cselect_b32 s57, 0, s57
    s_lshl_b32 s42, s57, 19
    v_mfma_f32_16x16x32_bf16 v[136:139], v[156:159], v[168:171], v[136:139]
    s_lshl_b32 s54, s57, 7
    s_add_u32 s42, s42, s55
    v_mfma_f32_16x16x32_bf16 v[140:143], v[156:159], v[172:175], v[140:143]
    s_add_u32 s54, s54, s45
    v_mfma_f32_16x16x32_bf16 v[144:147], v[156:159], v[176:179], v[144:147]
    s_waitcnt vmcnt(2) lgkmcnt(0)
    s_barrier
    s_cmp_lg_u32 s47, 2
    s_cbranch_scc1 L_p_nbx4
    s_add_u32 m0, s60, 155392
    s_add_u32 s38, s44, 0
    buffer_load_dwordx4 v227, s[8:11], s38 offen nt lds
    s_add_u32 m0, s60, 0
    s_add_u32 s38, s44, 8192
    buffer_load_dwordx4 v227, s[8:11], s38 offen nt lds
    s_add_u32 m0, s60, 16896
    s_add_u32 s38, s44, 0
    buffer_load_dwordx4 v227, s[12:15], s38 offen nt lds
    s_add_u32 m0, s60, 8448
    s_add_u32 s38, s44, 16384
    buffer_load_dwordx4 v227, s[8:11], s38 offen nt lds
    s_add_u32 m0, s60, 25344
    s_add_u32 s38, s44, 8192
    buffer_load_dwordx4 v227, s[12:15], s38 offen nt lds
    s_add_u32 m0, s60, 33792
    s_add_u32 s38, s44, 24576
    buffer_load_dwordx4 v227, s[8:11], s38 offen nt lds
    s_add_u32 m0, s60, 50688
    s_add_u32 s38, s44, 16384
    buffer_load_dwordx4 v227, s[12:15], s38 offen nt lds
    s_add_u32 m0, s60, 42240
    s_add_u32 s38, s44, 32768
    buffer_load_dwordx4 v227, s[8:11], s38 offen nt lds
    s_add_u32 m0, s60, 59136
    s_add_u32 s38, s44, 24576
    buffer_load_dwordx4 v227, s[12:15], s38 offen nt lds
L_p_nbx4:
    s_cmp_ge_u32 s32, 2
    s_cbranch_scc1 L_xx4
    s_add_u32 m0, s44, 152576
    s_add_u32 s39, s54, 73728
    buffer_load_dwordx4 v255, s[16:19], s39 offen lds
L_xx4:
    s_add_u32 m0, s44, 144384
    s_nop 0
    buffer_load_dwordx4 v255, s[16:19], s54 offen lds
    s_add_u32 m0, s43, 101376
    s_nop 0
    buffer_load_dwordx4 v253, s[20:23], s42 offen lds
    s_add_u32 m0, s43, 102400
    s_nop 0
    buffer_load_dwordx4 v254, s[20:23], s42 offen lds
    v_mfma_f32_16x16x32_bf16 v[108:111], v[184:187], v[192:195], v[108:111]
    ds_read_b128 v[160:163], v150 offset:0
    ds_read_b128 v[164:167], v150 offset:2048
    v_mfma_f32_16x16x32_bf16 v[112:115], v[184:187], v[196:199], v[112:115]
    ds_read_b128 v[168:171], v150 offset:4096
    ds_read_b128 v[172:175], v150 offset:6144
    v_mfma_f32_16x16x32_bf16 v[116:119], v[184:187], v[200:203], v[116:119]
    ds_read_b128 v[176:179], v150 offset:8192
    ds_read_b64_tr_b16 v[152:153], v148 offset:32768
    v_mfma_f32_16x16x32_bf16 v[120:123], v[184:187], v[204:207], v[120:123]
    ds_read_b64_tr_b16 v[154:155], v148 offset:34816
    ds_read_b64_tr_b16 v[156:157], v149 offset:32768
    v_mfma_f32_16x16x32_bf16 v[124:127], v[184:187], v[208:211], v[124:127]
    ds_read_b64_tr_b16 v[158:159], v149 offset:34816
    v_mfma_f32_16x16x32_bf16 v[128:131], v[188:191], v[192:195], v[128:131]
    v_mfma_f32_16x16x32_bf16 v[132:135], v[188:191], v[196:199], v[132:135]
    v_mfma_f32_16x16x32_bf16 v[136:139], v[188:191], v[200:203], v[136:139]
    v_mfma_f32_16x16x32_bf16 v[140:143], v[188:191], v[204:207], v[140:143]
    v_mfma_f32_16x16x32_bf16 v[144:147], v[188:191], v[208:211], v[144:147]
    s_waitcnt vmcnt(3) lgkmcnt(0)
    s_barrier
    s_add_u32 m0, s43, 117760
    s_nop 0
    buffer_load_dwordx4 v214, s[20:23], s42 offen lds
    s_add_u32 m0, s43, 118784
    s_nop 0
    buffer_load_dwordx4 v215, s[20:23], s42 offen lds
    v_mfma_f32_16x16x32_bf16 v[108:111], v[152:155], v[160:163], v[108:111]
    ds_read_b128 v[192:195], v151 offset:0
    ds_read_b128 v[196:199], v151 offset:2048
    v_mfma_f32_16x16x32_bf16 v[112:115], v[152:155], v[164:167], v[112:115]
    ds_read_b128 v[200:203], v151 offset:4096
    ds_read_b128 v[204:207], v151 offset:6144
    v_mfma_f32_16x16x32_bf16 v[116:119], v[152:155], v[168:171], v[116:119]
    ds_read_b128 v[208:211], v151 offset:8192
    ds_read_b64_tr_b16 v[184:185], v148 offset:0
    v_mfma_f32_16x16x32_bf16 v[120:123], v[152:155], v[172:175], v[120:123]
    ds_read_b64_tr_b16 v[186:187], v148 offset:2048
    ds_read_b64_tr_b16 v[188:189], v149 offset:0
    v_mfma_f32_16x16x32_bf16 v[124:127], v[152:155], v[176:179], v[124:127]
    ds_read_b64_tr_b16 v[190:191], v149 offset:2048
    v_mfma_f32_16x16x32_bf16 v[128:131], v[156:159], v[160:163], v[128:131]
    s_add_u32 s57, s57, 1
    s_cmp_eq_u32 s57, 9
    v_mfma_f32_16x16x32_bf16 v[132:135], v[156:159], v[164:167], v[132:135]
    s_cselect_b32 s57, 0, s57
    s_lshl_b32 s42, s57, 19
    v_mfma_f32_16x16x32_bf16 v[136:139], v[156:159], v[168:171], v[136:139]
    s_lshl_b32 s54, s57, 7
    s_add_u32 s42, s42, s55
    v_mfma_f32_16x16x32_bf16 v[140:143], v[156:159], v[172:175], v[140:143]
    s_add_u32 s54, s54, s45
    v_mfma_f32_16x16x32_bf16 v[144:147], v[156:159], v[176:179], v[144:147]
    s_waitcnt vmcnt(2) lgkmcnt(0)
    s_barrier
    s_cmp_ge_u32 s32, 2
    s_cbranch_scc1 L_xx6
    s_add_u32 m0, s44, 142336
    s_add_u32 s39, s54, 73728
    buffer_load_dwordx4 v255, s[16:19], s39 offen lds
L_xx6:
    s_add_u32 m0, s44, 134144
    s_nop 0
    buffer_load_dwordx4 v255, s[16:19], s54 offen lds
    s_add_u32 m0, s43, 84992
    s_nop 0
    buffer_load_dwordx4 v253, s[20:23], s42 offen lds
    s_add_u32 m0, s43, 86016
    s_nop 0
    buffer_load_dwordx4 v254, s[20:23], s42 offen lds
    v_mfma_f32_16x16x32_bf16 v[108:111], v[184:187], v[192:195], v[108:111]
    ds_read_b128 v[160:163], v150 offset:10240
    ds_read_b128 v[164:167], v150 offset:12288
    v_mfma_f32_16x16x32_bf16 v[112:115], v[184:187], v[196:199], v[112:115]
    ds_read_b128 v[168:171], v150 offset:14336
    ds_read_b128 v[172:175], v150 offset:16384
    v_mfma_f32_16x16x32_bf16 v[116:119], v[184:187], v[200:203], v[116:119]
    ds_read_b128 v[176:179], v150 offset:18432
    ds_read_b64_tr_b16 v[152:153], v148 offset:16384
    v_mfma_f32_16x16x32_bf16 v[120:123], v[184:187], v[204:207], v[120:123]
    ds_read_b64_tr_b16 v[154:155], v148 offset:18432
    ds_read_b64_tr_b16 v[156:157], v149 offset:16384
    v_mfma_f32_16x16x32_bf16 v[124:127], v[184:187], v[208:211], v[124:127]
    ds_read_b64_tr_b16 v[158:159], v149 offset:18432
    v_mfma_f32_16x16x32_bf16 v[128:131], v[188:191], v[192:195], v[128:131]
    v_mfma_f32_16x16x32_bf16 v[132:135], v[188:191], v[196:199], v[132:135]
    v_mfma_f32_16x16x32_bf16 v[136:139], v[188:191], v[200:203], v[136:139]
    v_mfma_f32_16x16x32_bf16 v[140:143], v[188:191], v[204:207], v[140:143]
    v_mfma_f32_16x16x32_bf16 v[144:147], v[188:191], v[208:211], v[144:147]
    s_waitcnt vmcnt(3) lgkmcnt(0)
    s_barrier
    s_add_u32 m0, s43, 101376
    s_nop 0
    buffer_load_dwordx4 v214, s[20:23], s42 offen lds
    s_add_u32 m0, s43, 102400
    s_nop 0
    buffer_load_dwordx4 v215, s[20:23], s42 offen lds
    v_mfma_f32_16x16x32_bf16 v[108:111], v[152:155], v[160:163], v[108:111]
    ds_read_b128 v[192:195], v151 offset:10240
    ds_read_b128 v[196:199], v151 offset:12288
    v_mfma_f32_16x16x32_bf16 v[112:115], v[152:155], v[164:167], v[112:115]
    ds_read_b128 v[200:203], v151 offset:14336
    ds_read_b128 v[204:207], v151 offset:16384
    v_mfma_f32_16x16x32_bf16 v[116:119], v[152:155], v[168:171], v[116:119]
    ds_read_b128 v[208:211], v151 offset:18432
    ds_read_b64_tr_b16 v[184:185], v148 offset:32768
    v_mfma_f32_16x16x32_bf16 v[120:123], v[152:155], v[172:175], v[120:123]
    ds_read_b64_tr_b16 v[186:187], v148 offset:34816
    ds_read_b64_tr_b16 v[188:189], v149 offset:32768
    v_mfma_f32_16x16x32_bf16 v[124:127], v[152:155], v[176:179], v[124:127]
    ds_read_b64_tr_b16 v[190:191], v149 offset:34816
    v_mfma_f32_16x16x32_bf16 v[128:131], v[156:159], v[160:163], v[128:131]
    s_add_u32 s57, s57, 1
    s_cmp_eq_u32 s57, 9
    v_mfma_f32_16x16x32_bf16 v[132:135], v[156:159], v[164:167], v[132:135]
    s_cselect_b32 s57, 0, s57
    s_lshl_b32 s42, s57, 19
    v_mfma_f32_16x16x32_bf16 v[136:139], v[156:159], v[168:171], v[136:139]
    s_lshl_b32 s54, s57, 7
    s_add_u32 s42, s42, s55
    v_mfma_f32_16x16x32_bf16 v[140:143], v[156:159], v[172:175], v[140:143]
    s_add_u32 s54, s54, s45
    v_mfma_f32_16x16x32_bf16 v[144:147], v[156:159], v[176:179], v[144:147]
    s_waitcnt vmcnt(2) lgkmcnt(0)
    s_barrier
    s_cmp_lg_u32 s47, 4
    s_cbranch_scc1 L_p_nbx8
    s_add_u32 m0, s60, 155392
    s_add_u32 s38, s44, 0
    buffer_load_dwordx4 v227, s[8:11], s38 offen nt lds
    s_add_u32 m0, s60, 0
    s_add_u32 s38, s44, 8192
    buffer_load_dwordx4 v227, s[8:11], s38 offen nt lds
    s_add_u32 m0, s60, 16896
    s_add_u32 s38, s44, 0
    buffer_load_dwordx4 v227, s[12:15], s38 offen nt lds
    s_add_u32 m0, s60, 8448
    s_add_u32 s38, s44, 16384
    buffer_load_dwordx4 v227, s[8:11], s38 offen nt lds
    s_add_u32 m0, s60, 25344
    s_add_u32 s38, s44, 8192
    buffer_load_dwordx4 v227, s[12:15], s38 offen nt lds
    s_add_u32 m0, s60, 33792
    s_add_u32 s38, s44, 24576
    buffer_load_dwordx4 v227, s[8:11], s38 offen nt lds
    s_add_u32 m0, s60, 50688
    s_add_u32 s38, s44, 16384
    buffer_load_dwordx4 v227, s[12:15], s38 offen nt lds
    s_add_u32 m0, s60, 42240
    s_add_u32 s38, s44, 32768
    buffer_load_dwordx4 v227, s[8:11], s38 offen nt lds
    s_add_u32 m0, s60, 59136
    s_add_u32 s38, s44, 24576
    buffer_load_dwordx4 v227, s[12:15], s38 offen nt lds
L_p_nbx8:
    s_cmp_ge_u32 s32, 2
    s_cbranch_scc1 L_xx8
    s_add_u32 m0, s44, 152576
    s_add_u32 s39, s54, 73728
    buffer_load_dwordx4 v255, s[16:19], s39 offen lds
L_xx8:
    s_add_u32 m0, s44, 144384
    s_nop 0
    buffer_load_dwordx4 v255, s[16:19], s54 offen lds
    s_add_u32 m0, s43, 117760
    s_nop 0
    buffer_load_dwordx4 v253, s[20:23], s42 offen lds
    s_add_u32 m0, s43, 118784
    s_nop 0
    buffer_load_dwordx4 v254, s[20:23], s42 offen lds
    v_mfma_f32_16x16x32_bf16 v[108:111], v[184:187], v[192:195], v[108:111]
    ds_read_b128 v[160:163], v150 offset:0
    ds_read_b128 v[164:167], v150 offset:2048
    v_mfma_f32_16x16x32_bf16 v[112:115], v[184:187], v[196:199], v[112:115]
    ds_read_b128 v[168:171], v150 offset:4096
    ds_read_b128 v[172:175], v150 offset:6144
    v_mfma_f32_16x16x32_bf16 v[116:119], v[184:187], v[200:203], v[116:119]
    ds_read_b128 v[176:179], v150 offset:8192
    ds_read_b64_tr_b16 v[152:153], v148 offset:0
    v_mfma_f32_16x16x32_bf16 v[120:123], v[184:187], v[204:207], v[120:123]
    ds_read_b64_tr_b16 v[154:155], v148 offset:2048
    ds_read_b64_tr_b16 v[156:157], v149 offset:0
    v_mfma_f32_16x16x32_bf16 v[124:127], v[184:187], v[208:211], v[124:127]
    ds_read_b64_tr_b16 v[158:159], v149 offset:2048
    v_mfma_f32_16x16x32_bf16 v[128:131], v[188:191], v[192:195], v[128:131]
    v_mfma_f32_16x16x32_bf16 v[132:135], v[188:191], v[196:199], v[132:135]
    v_mfma_f32_16x16x32_bf16 v[136:139], v[188:191], v[200:203], v[136:139]
    v_mfma_f32_16x16x32_bf16 v[140:143], v[188:191], v[204:207], v[140:143]
    v_mfma_f32_16x16x32_bf16 v[144:147], v[188:191], v[208:211], v[144:147]
    s_waitcnt vmcnt(3) lgkmcnt(0)
    s_barrier
    s_add_u32 m0, s43, 84992
    s_nop 0
    buffer_load_dwordx4 v214, s[20:23], s42 offen lds
    s_add_u32 m0, s43, 86016
    s_nop 0
    buffer_load_dwordx4 v215, s[20:23], s42 offen lds
    v_mfma_f32_16x16x32_bf16 v[108:111], v[152:155], v[160:163], v[108:111]
    ds_read_b128 v[192:195], v151 offset:0
    ds_read_b128 v[196:199], v151 offset:2048
    v_mfma_f32_16x16x32_bf16 v[112:115], v[152:155], v[164:167], v[112:115]
    ds_read_b128 v[200:203], v151 offset:4096
    ds_read_b128 v[204:207], v151 offset:6144
    v_mfma_f32_16x16x32_bf16 v[116:119], v[152:155], v[168:171], v[116:119]
    ds_read_b128 v[208:211], v151 offset:8192
    ds_read_b64_tr_b16 v[184:185], v148 offset:16384
    v_mfma_f32_16x16x32_bf16 v[120:123], v[152:155], v[172:175], v[120:123]
    ds_read_b64_tr_b16 v[186:187], v148 offset:18432
    ds_read_b64_tr_b16 v[188:189], v149 offset:16384
    v_mfma_f32_16x16x32_bf16 v[124:127], v[152:155], v[176:179], v[124:127]
    ds_read_b64_tr_b16 v[190:191], v149 offset:18432
    v_mfma_f32_16x16x32_bf16 v[128:131], v[156:159], v[160:163], v[128:131]
    s_add_u32 s57, s57, 1
    s_cmp_eq_u32 s57, 9
    v_mfma_f32_16x16x32_bf16 v[132:135], v[156:159], v[164:167], v[132:135]
    s_cselect_b32 s57, 0, s57
    s_lshl_b32 s42, s57, 19
    v_mfma_f32_16x16x32_bf16 v[136:139], v[156:159], v[168:171], v[136:139]
    s_lshl_b32 s54, s57, 7
    s_add_u32 s42, s42, s55
    v_mfma_f32_16x16x32_bf16 v[140:143], v[156:159], v[172:175], v[140:143]
    s_add_u32 s54, s54, s45
    v_mfma_f32_16x16x32_bf16 v[144:147], v[156:159], v[176:179], v[144:147]
    s_waitcnt vmcnt(2) lgkmcnt(0)
    s_barrier
    s_cmp_ge_u32 s32, 2
    s_cbranch_scc1 L_xx10
    s_add_u32 m0, s44, 142336
    s_add_u32 s39, s54, 73728
    buffer_load_dwordx4 v255, s[16:19], s39 offen lds
L_xx10:
    s_add_u32 m0, s44, 134144
    s_nop 0
    buffer_load_dwordx4 v255, s[16:19], s54 offen lds
    s_add_u32 m0, s43, 101376
    s_nop 0
    buffer_load_dwordx4 v253, s[20:23], s42 offen lds
    s_add_u32 m0, s43, 102400
    s_nop 0
    buffer_load_dwordx4 v254, s[20:23], s42 offen lds
    v_mfma_f32_16x16x32_bf16 v[108:111], v[184:187], v[192:195], v[108:111]
    ds_read_b128 v[160:163], v150 offset:10240
    ds_read_b128 v[164:167], v150 offset:12288
    v_mfma_f32_16x16x32_bf16 v[112:115], v[184:187], v[196:199], v[112:115]
    ds_read_b128 v[168:171], v150 offset:14336
    ds_read_b128 v[172:175], v150 offset:16384
    v_mfma_f32_16x16x32_bf16 v[116:119], v[184:187], v[200:203], v[116:119]
    ds_read_b128 v[176:179], v150 offset:18432
    ds_read_b64_tr_b16 v[152:153], v148 offset:32768
    v_mfma_f32_16x16x32_bf16 v[120:123], v[184:187], v[204:207], v[120:123]
    ds_read_b64_tr_b16 v[154:155], v148 offset:34816
    ds_read_b64_tr_b16 v[156:157], v149 offset:32768
    v_mfma_f32_16x16x32_bf16 v[124:127], v[184:187], v[208:211], v[124:127]
    ds_read_b64_tr_b16 v[158:159], v149 offset:34816
    v_mfma_f32_16x16x32_bf16 v[128:131], v[188:191], v[192:195], v[128:131]
    v_mfma_f32_16x16x32_bf16 v[132:135], v[188:191], v[196:199], v[132:135]
    v_mfma_f32_16x16x32_bf16 v[136:139], v[188:191], v[200:203], v[136:139]
    v_mfma_f32_16x16x32_bf16 v[140:143], v[188:191], v[204:207], v[140:143]
    v_mfma_f32_16x16x32_bf16 v[144:147], v[188:191], v[208:211], v[144:147]
    s_waitcnt vmcnt(3) lgkmcnt(0)
    s_barrier
    s_add_u32 m0, s43, 117760
    s_nop 0
    buffer_load_dwordx4 v214, s[20:23], s42 offen lds
    s_add_u32 m0, s43, 118784
    s_nop 0
    buffer_load_dwordx4 v215, s[20:23], s42 offen lds
    v_mfma_f32_16x16x32_bf16 v[108:111], v[152:155], v[160:163], v[108:111]
    ds_read_b128 v[192:195], v151 offset:10240
    ds_read_b128 v[196:199], v151 offset:12288
    v_mfma_f32_16x16x32_bf16 v[112:115], v[152:155], v[164:167], v[112:115]
    ds_read_b128 v[200:203], v151 offset:14336
    ds_read_b128 v[204:207], v151 offset:16384
    v_mfma_f32_16x16x32_bf16 v[116:119], v[152:155], v[168:171], v[116:119]
    ds_read_b128 v[208:211], v151 offset:18432
    ds_read_b64_tr_b16 v[184:185], v148 offset:0
    v_mfma_f32_16x16x32_bf16 v[120:123], v[152:155], v[172:175], v[120:123]
    ds_read_b64_tr_b16 v[186:187], v148 offset:2048
    ds_read_b64_tr_b16 v[188:189], v149 offset:0
    v_mfma_f32_16x16x32_bf16 v[124:127], v[152:155], v[176:179], v[124:127]
    ds_read_b64_tr_b16 v[190:191], v149 offset:2048
    v_mfma_f32_16x16x32_bf16 v[128:131], v[156:159], v[160:163], v[128:131]
    s_add_u32 s57, s57, 1
    s_cmp_eq_u32 s57, 9
    v_mfma_f32_16x16x32_bf16 v[132:135], v[156:159], v[164:167], v[132:135]
    s_cselect_b32 s57, 0, s57
    s_lshl_b32 s42, s57, 19
    v_mfma_f32_16x16x32_bf16 v[136:139], v[156:159], v[168:171], v[136:139]
    s_lshl_b32 s54, s57, 7
    s_add_u32 s42, s42, s55
    v_mfma_f32_16x16x32_bf16 v[140:143], v[156:159], v[172:175], v[140:143]
    s_add_u32 s54, s54, s45
    v_mfma_f32_16x16x32_bf16 v[144:147], v[156:159], v[176:179], v[144:147]
    s_waitcnt vmcnt(2) lgkmcnt(0)
    s_barrier
    s_cmp_ge_u32 s32, 2
    s_cbranch_scc1 L_xx12
    s_add_u32 m0, s44, 152576
    s_add_u32 s39, s54, 73728
    buffer_load_dwordx4 v255, s[16:19], s39 offen lds
L_xx12:
    s_add_u32 m0, s44, 144384
    s_nop 0
    buffer_load_dwordx4 v255, s[16:19], s54 offen lds
    s_add_u32 m0, s43, 84992
    s_nop 0
    buffer_load_dwordx4 v253, s[20:23], s42 offen lds
    s_add_u32 m0, s43, 86016
    s_nop 0
    buffer_load_dwordx4 v254, s[20:23], s42 offen lds
    v_mfma_f32_16x16x32_bf16 v[108:111], v[184:187], v[192:195], v[108:111]
    ds_read_b128 v[160:163], v150 offset:0
    ds_read_b128 v[164:167], v150 offset:2048
    v_mfma_f32_16x16x32_bf16 v[112:115], v[184:187], v[196:199], v[112:115]
    ds_read_b128 v[168:171], v150 offset:4096
    ds_read_b128 v[172:175], v150 offset:6144
    v_mfma_f32_16x16x32_bf16 v[116:119], v[184:187], v[200:203], v[116:119]
    ds_read_b128 v[176:179], v150 offset:8192
    ds_read_b64_tr_b16 v[152:153], v148 offset:16384
    v_mfma_f32_16x16x32_bf16 v[120:123], v[184:187], v[204:207], v[120:123]
    ds_read_b64_tr_b16 v[154:155], v148 offset:18432
    ds_read_b64_tr_b16 v[156:157], v149 offset:16384
    v_mfma_f32_16x16x32_bf16 v[124:127], v[184:187], v[208:211], v[124:127]
    ds_read_b64_tr_b16 v[158:159], v149 offset:18432
    v_mfma_f32_16x16x32_bf16 v[128:131], v[188:191], v[192:195], v[128:131]
    v_mfma_f32_16x16x32_bf16 v[132:135], v[188:191], v[196:199], v[132:135]
    v_mfma_f32_16x16x32_bf16 v[136:139], v[188:191], v[200:203], v[136:139]
    v_mfma_f32_16x16x32_bf16 v[140:143], v[188:191], v[204:207], v[140:143]
    v_mfma_f32_16x16x32_bf16 v[144:147], v[188:191], v[208:211], v[144:147]
    s_waitcnt vmcnt(3) lgkmcnt(0)
    s_barrier
    s_add_u32 m0, s43, 101376
    s_nop 0
    buffer_load_dwordx4 v214, s[20:23], s42 offen lds
    s_add_u32 m0, s43, 102400
    s_nop 0
    buffer_load_dwordx4 v215, s[20:23], s42 offen lds
    v_mfma_f32_16x16x32_bf16 v[108:111], v[152:155], v[160:163], v[108:111]
    ds_read_b128 v[192:195], v151 offset:0
    ds_read_b128 v[196:199], v151 offset:2048
    v_mfma_f32_16x16x32_bf16 v[112:115], v[152:155], v[164:167], v[112:115]
    ds_read_b128 v[200:203], v151 offset:4096
    ds_read_b128 v[204:207], v151 offset:6144
    v_mfma_f32_16x16x32_bf16 v[116:119], v[152:155], v[168:171], v[116:119]
    ds_read_b128 v[208:211], v151 offset:8192
    ds_read_b64_tr_b16 v[184:185], v148 offset:32768
    v_mfma_f32_16x16x32_bf16 v[120:123], v[152:155], v[172:175], v[120:123]
    ds_read_b64_tr_b16 v[186:187], v148 offset:34816
    ds_read_b64_tr_b16 v[188:189], v149 offset:32768
    v_mfma_f32_16x16x32_bf16 v[124:127], v[152:155], v[176:179], v[124:127]
    ds_read_b64_tr_b16 v[190:191], v149 offset:34816
    v_mfma_f32_16x16x32_bf16 v[128:131], v[156:159], v[160:163], v[128:131]
    s_add_u32 s57, s57, 1
    s_cmp_eq_u32 s57, 9
    v_mfma_f32_16x16x32_bf16 v[132:135], v[156:159], v[164:167], v[132:135]
    s_cselect_b32 s57, 0, s57
    s_lshl_b32 s42, s57, 19
    v_mfma_f32_16x16x32_bf16 v[136:139], v[156:159], v[168:171], v[136:139]
    s_lshl_b32 s54, s57, 7
    s_add_u32 s42, s42, s55
    v_mfma_f32_16x16x32_bf16 v[140:143], v[156:159], v[172:175], v[140:143]
    s_add_u32 s54, s54, s45
    v_mfma_f32_16x16x32_bf16 v[144:147], v[156:159], v[176:179], v[144:147]
    s_waitcnt vmcnt(2) lgkmcnt(0)
    s_barrier
    s_cmp_ge_u32 s32, 2
    s_cbranch_scc1 L_xx14
    s_add_u32 m0, s44, 142336
    s_add_u32 s39, s54, 73728
    buffer_load_dwordx4 v255, s[16:19], s39 offen lds
L_xx14:
    s_add_u32 m0, s44, 134144
    s_nop 0
    buffer_load_dwordx4 v255, s[16:19], s54 offen lds
    s_add_u32 m0, s43, 117760
    s_nop 0
    buffer_load_dwordx4 v253, s[20:23], s42 offen lds
    s_add_u32 m0, s43, 118784
    s_nop 0
    buffer_load_dwordx4 v254, s[20:23], s42 offen lds
    v_mfma_f32_16x16x32_bf16 v[108:111], v[184:187], v[192:195], v[108:111]
    ds_read_b128 v[160:163], v150 offset:10240
    ds_read_b128 v[164:167], v150 offset:12288
    v_mfma_f32_16x16x32_bf16 v[112:115], v[184:187], v[196:199], v[112:115]
    ds_read_b128 v[168:171], v150 offset:14336
    ds_read_b128 v[172:175], v150 offset:16384
    v_mfma_f32_16x16x32_bf16 v[116:119], v[184:187], v[200:203], v[116:119]
    ds_read_b128 v[176:179], v150 offset:18432
    ds_read_b64_tr_b16 v[152:153], v148 offset:0
    v_mfma_f32_16x16x32_bf16 v[120:123], v[184:187], v[204:207], v[120:123]
    ds_read_b64_tr_b16 v[154:155], v148 offset:2048
    ds_read_b64_tr_b16 v[156:157], v149 offset:0
    v_mfma_f32_16x16x32_bf16 v[124:127], v[184:187], v[208:211], v[124:127]
    ds_read_b64_tr_b16 v[158:159], v149 offset:2048
    v_mfma_f32_16x16x32_bf16 v[128:131], v[188:191], v[192:195], v[128:131]
    v_mfma_f32_16x16x32_bf16 v[132:135], v[188:191], v[196:199], v[132:135]
    v_mfma_f32_16x16x32_bf16 v[136:139], v[188:191], v[200:203], v[136:139]
    v_mfma_f32_16x16x32_bf16 v[140:143], v[188:191], v[204:207], v[140:143]
    v_mfma_f32_16x16x32_bf16 v[144:147], v[188:191], v[208:211], v[144:147]
    s_waitcnt vmcnt(3) lgkmcnt(0)
    s_barrier
    s_add_u32 m0, s43, 84992
    s_nop 0
    buffer_load_dwordx4 v214, s[20:23], s42 offen lds
    s_add_u32 m0, s43, 86016
    s_nop 0
    buffer_load_dwordx4 v215, s[20:23], s42 offen lds
    v_mfma_f32_16x16x32_bf16 v[108:111], v[152:155], v[160:163], v[108:111]
    ds_read_b128 v[192:195], v151 offset:10240
    ds_read_b128 v[196:199], v151 offset:12288
    v_mfma_f32_16x16x32_bf16 v[112:115], v[152:155], v[164:167], v[112:115]
    ds_read_b128 v[200:203], v151 offset:14336
    ds_read_b128 v[204:207], v151 offset:16384
    v_mfma_f32_16x16x32_bf16 v[116:119], v[152:155], v[168:171], v[116:119]
    ds_read_b128 v[208:211], v151 offset:18432
    ds_read_b64_tr_b16 v[184:185], v148 offset:16384
    v_mfma_f32_16x16x32_bf16 v[120:123], v[152:155], v[172:175], v[120:123]
    ds_read_b64_tr_b16 v[186:187], v148 offset:18432
    ds_read_b64_tr_b16 v[188:189], v149 offset:16384
    v_mfma_f32_16x16x32_bf16 v[124:127], v[152:155], v[176:179], v[124:127]
    ds_read_b64_tr_b16 v[190:191], v149 offset:18432
    v_mfma_f32_16x16x32_bf16 v[128:131], v[156:159], v[160:163], v[128:131]
    v_mfma_f32_16x16x32_bf16 v[132:135], v[156:159], v[164:167], v[132:135]
    v_mfma_f32_16x16x32_bf16 v[136:139], v[156:159], v[168:171], v[136:139]
    v_mfma_f32_16x16x32_bf16 v[140:143], v[156:159], v[172:175], v[140:143]
    v_mfma_f32_16x16x32_bf16 v[144:147], v[156:159], v[176:179], v[144:147]
    s_waitcnt vmcnt(2) lgkmcnt(0)
    s_barrier
    v_mfma_f32_16x16x32_bf16 v[108:111], v[184:187], v[192:195], v[108:111]
    ds_read_b128 v[160:163], v150 offset:0
    ds_read_b128 v[164:167], v150 offset:2048
    v_mfma_f32_16x16x32_bf16 v[112:115], v[184:187], v[196:199], v[112:115]
    ds_read_b128 v[168:171], v150 offset:4096
    ds_read_b128 v[172:175], v150 offset:6144
    v_mfma_f32_16x16x32_bf16 v[116:119], v[184:187], v[200:203], v[116:119]
    ds_read_b128 v[176:179], v150 offset:8192
    ds_read_b64_tr_b16 v[152:153], v148 offset:32768
    v_mfma_f32_16x16x32_bf16 v[120:123], v[184:187], v[204:207], v[120:123]
    ds_read_b64_tr_b16 v[154:155], v148 offset:34816
    ds_read_b64_tr_b16 v[156:157], v149 offset:32768
    v_mfma_f32_16x16x32_bf16 v[124:127], v[184:187], v[208:211], v[124:127]
    ds_read_b64_tr_b16 v[158:159], v149 offset:34816
    v_mfma_f32_16x16x32_bf16 v[128:131], v[188:191], v[192:195], v[128:131]
    v_mfma_f32_16x16x32_bf16 v[132:135], v[188:191], v[196:199], v[132:135]
    v_mfma_f32_16x16x32_bf16 v[136:139], v[188:191], v[200:203], v[136:139]
    v_mfma_f32_16x16x32_bf16 v[140:143], v[188:191], v[204:207], v[140:143]
    v_mfma_f32_16x16x32_bf16 v[144:147], v[188:191], v[208:211], v[144:147]
    s_cmp_lg_u32 s47, 8
    s_cbranch_scc1 L_p_b1x
    s_add_u32 m0, s60, 155392
    s_add_u32 s38, s44, 0
    buffer_load_dwordx4 v227, s[8:11], s38 offen nt lds
    s_add_u32 m0, s60, 0
    s_add_u32 s38, s44, 8192
    buffer_load_dwordx4 v227, s[8:11], s38 offen nt lds
    s_add_u32 m0, s60, 16896
    s_add_u32 s38, s44, 0
    buffer_load_dwordx4 v227, s[12:15], s38 offen nt lds
    s_waitcnt vmcnt(3) lgkmcnt(0)
    s_branch L_p_b2x
L_p_b1x:
    s_bitcmp1_b32 s33, 0
    s_cbranch_scc1 L_p_b4x
    s_mul_i32 s39, s32, 9216
    s_and_b32 s38, s33, 7
    s_lshr_b32 s38, s38, 1
    s_mul_i32 s38, s38, 73728
    s_add_u32 s38, s38, s39
    s_and_b32 s39, s34, 1
    s_mul_i32 s39, s39, 294912
    s_add_u32 s38, s38, s39
    v_lshlrev_b32 v233, 7, v216
    v_and_b32 v234, 7, v216
    v_lshlrev_b32 v234, 7, v234
    v_add_u32 v234, 8192, v234
    buffer_load_dword v229, v233, s[24:27], s38 offen
    buffer_load_dword v229, v234, s[24:27], s38 offen
    s_waitcnt vmcnt(2) lgkmcnt(0)
    s_branch L_p_b2x
L_p_b4x:
    s_waitcnt vmcnt(0) lgkmcnt(0)
L_p_b2x:
    s_barrier
    v_mfma_f32_16x16x32_bf16 v[108:111], v[152:155], v[160:163], v[108:111]
    ds_read_b128 v[192:195], v151 offset:0
    ds_read_b128 v[196:199], v151 offset:2048
    v_mfma_f32_16x16x32_bf16 v[112:115], v[152:155], v[164:167], v[112:115]
    ds_read_b128 v[200:203], v151 offset:4096
    ds_read_b128 v[204:207], v151 offset:6144
    v_mfma_f32_16x16x32_bf16 v[116:119], v[152:155], v[168:171], v[116:119]
    ds_read_b128 v[208:211], v151 offset:8192
    ds_read_b64_tr_b16 v[184:185], v148 offset:0
    v_mfma_f32_16x16x32_bf16 v[120:123], v[152:155], v[172:175], v[120:123]
    ds_read_b64_tr_b16 v[186:187], v148 offset:2048
    ds_read_b64_tr_b16 v[188:189], v149 offset:0
    v_mfma_f32_16x16x32_bf16 v[124:127], v[152:155], v[176:179], v[124:127]
    ds_read_b64_tr_b16 v[190:191], v149 offset:2048
    v_mfma_f32_16x16x32_bf16 v[128:131], v[156:159], v[160:163], v[128:131]
    v_mfma_f32_16x16x32_bf16 v[132:135], v[156:159], v[164:167], v[132:135]
    v_mfma_f32_16x16x32_bf16 v[136:139], v[156:159], v[168:171], v[136:139]
    v_mfma_f32_16x16x32_bf16 v[140:143], v[156:159], v[172:175], v[140:143]
    v_mfma_f32_16x16x32_bf16 v[144:147], v[156:159], v[176:179], v[144:147]
    s_branch L_p_fin
L_p_y:
    s_barrier
    ds_read_b128 v[160:163], v150 offset:0
    ds_read_b128 v[164:167], v150 offset:2048
    ds_read_b128 v[168:171], v150 offset:4096
    ds_read_b128 v[172:175], v150 offset:6144
    ds_read_b128 v[176:179], v150 offset:8192
    ds_read_b64_tr_b16 v[152:153], v148 offset:16384
    ds_read_b64_tr_b16 v[154:155], v148 offset:18432
    ds_read_b64_tr_b16 v[156:157], v149 offset:16384
    ds_read_b64_tr_b16 v[158:159], v149 offset:18432
    s_waitcnt vmcnt(3) lgkmcnt(0)
    s_barrier
    v_mfma_f32_16x16x32_bf16 v[108:111], v[152:155], v[160:163], 0
    ds_read_b128 v[192:195], v151 offset:0
    v_mfma_f32_16x16x32_bf16 v[112:115], v[152:155], v[164:167], 0
    ds_read_b128 v[196:199], v151 offset:2048
    v_mfma_f32_16x16x32_bf16 v[116:119], v[152:155], v[168:171], 0
    ds_read_b128 v[200:203], v151 offset:4096
    v_mfma_f32_16x16x32_bf16 v[120:123], v[152:155], v[172:175], 0
    ds_read_b128 v[204:207], v151 offset:6144
    v_mfma_f32_16x16x32_bf16 v[124:127], v[152:155], v[176:179], 0
    ds_read_b128 v[208:211], v151 offset:8192
    v_mfma_f32_16x16x32_bf16 v[128:131], v[156:159], v[160:163], 0
    ds_read_b64_tr_b16 v[184:185], v148 offset:32768
    v_mfma_f32_16x16x32_bf16 v[132:135], v[156:159], v[164:167], 0
    ds_read_b64_tr_b16 v[186:187], v148 offset:34816
    v_mfma_f32_16x16x32_bf16 v[136:139], v[156:159], v[168:171], 0
    ds_read_b64_tr_b16 v[188:189], v149 offset:32768
    v_mfma_f32_16x16x32_bf16 v[140:143], v[156:159], v[172:175], 0
    ds_read_b64_tr_b16 v[190:191], v149 offset:34816
    v_mfma_f32_16x16x32_bf16 v[144:147], v[156:159], v[176:179], 0
    s_add_u32 m0, s43, 101376
    s_nop 0
    buffer_load_dwordx4 v214, s[20:23], s42 offen lds
    s_add_u32 m0, s43, 102400
    s_nop 0
    buffer_load_dwordx4 v215, s[20:23], s42 offen lds
    s_add_u32 s57, s57, 1
    s_cmp_eq_u32 s57, 9
    s_cselect_b32 s57, 0, s57
    s_lshl_b32 s42, s57, 19
    s_lshl_b32 s54, s57, 7
    s_add_u32 s42, s42, s55
    s_add_u32 s54, s54, s45
    s_waitcnt vmcnt(2) lgkmcnt(0)
    s_barrier
    v_mfma_f32_16x16x32_bf16 v[108:111], v[184:187], v[192:195], v[108:111]
    ds_read_b128 v[160:163], v150 offset:10240
    v_mfma_f32_16x16x32_bf16 v[112:115], v[184:187], v[196:199], v[112:115]
    ds_read_b128 v[164:167], v150 offset:12288
    v_mfma_f32_16x16x32_bf16 v[116:119], v[184:187], v[200:203], v[116:119]
    ds_read_b128 v[168:171], v150 offset:14336
    v_mfma_f32_16x16x32_bf16 v[120:123], v[184:187], v[204:207], v[120:123]
    ds_read_b128 v[172:175], v150 offset:16384
    v_mfma_f32_16x16x32_bf16 v[124:127], v[184:187], v[208:211], v[124:127]
    ds_read_b128 v[176:179], v150 offset:18432
    v_mfma_f32_16x16x32_bf16 v[128:131], v[188:191], v[192:195], v[128:131]
    ds_read_b64_tr_b16 v[152:153], v148 offset:0
    v_mfma_f32_16x16x32_bf16 v[132:135], v[188:191], v[196:199], v[132:135]
    ds_read_b64_tr_b16 v[154:155], v148 offset:2048
    v_mfma_f32_16x16x32_bf16 v[136:139], v[188:191], v[200:203], v[136:139]
    ds_read_b64_tr_b16 v[156:157], v149 offset:0
    v_mfma_f32_16x16x32_bf16 v[140:143], v[188:191], v[204:207], v[140:143]
    ds_read_b64_tr_b16 v[158:159], v149 offset:2048
    v_mfma_f32_16x16x32_bf16 v[144:147], v[188:191], v[208:211], v[144:147]
    s_add_u32 m0, s44, 134144
    s_nop 0
    buffer_load_dwordx4 v255, s[16:19], s54 offen lds
    s_add_u32 m0, s43, 117760
    s_nop 0
    buffer_load_dwordx4 v253, s[20:23], s42 offen lds
    s_add_u32 m0, s43, 118784
    s_nop 0
    buffer_load_dwordx4 v254, s[20:23], s42 offen lds
    s_waitcnt vmcnt(3) lgkmcnt(0)
    s_barrier
    v_mfma_f32_16x16x32_bf16 v[108:111], v[152:155], v[160:163], v[108:111]
    ds_read_b128 v[192:195], v151 offset:10240
    v_mfma_f32_16x16x32_bf16 v[112:115], v[152:155], v[164:167], v[112:115]
    ds_read_b128 v[196:199], v151 offset:12288
    v_mfma_f32_16x16x32_bf16 v[116:119], v[152:155], v[168:171], v[116:119]
    ds_read_b128 v[200:203], v151 offset:14336
    v_mfma_f32_16x16x32_bf16 v[120:123], v[152:155], v[172:175], v[120:123]
    ds_read_b128 v[204:207], v151 offset:16384
    v_mfma_f32_16x16x32_bf16 v[124:127], v[152:155], v[176:179], v[124:127]
    ds_read_b128 v[208:211], v151 offset:18432
    v_mfma_f32_16x16x32_bf16 v[128:131], v[156:159], v[160:163], v[128:131]
    ds_read_b64_tr_b16 v[184:185], v148 offset:16384
    v_mfma_f32_16x16x32_bf16 v[132:135], v[156:159], v[164:167], v[132:135]
    ds_read_b64_tr_b16 v[186:187], v148 offset:18432
    v_mfma_f32_16x16x32_bf16 v[136:139], v[156:159], v[168:171], v[136:139]
    ds_read_b64_tr_b16 v[188:189], v149 offset:16384
    v_mfma_f32_16x16x32_bf16 v[140:143], v[156:159], v[172:175], v[140:143]
    ds_read_b64_tr_b16 v[190:191], v149 offset:18432
    v_mfma_f32_16x16x32_bf16 v[144:147], v[156:159], v[176:179], v[144:147]
    s_add_u32 m0, s43, 84992
    s_nop 0
    buffer_load_dwordx4 v214, s[20:23], s42 offen lds
    s_add_u32 m0, s43, 86016
    s_nop 0
    buffer_load_dwordx4 v215, s[20:23], s42 offen lds
    s_add_u32 s57, s57, 1
    s_cmp_eq_u32 s57, 9
    s_cselect_b32 s57, 0, s57
    s_lshl_b32 s42, s57, 19
    s_lshl_b32 s54, s57, 7
    s_add_u32 s42, s42, s55
    s_add_u32 s54, s54, s45
    s_waitcnt vmcnt(2) lgkmcnt(0)
    s_barrier
    s_cmp_lg_u32 s47, 2
    s_cbranch_scc1 L_p_nby4
    s_add_u32 m0, s60, 155392
    s_add_u32 s38, s44, 0
    buffer_load_dwordx4 v227, s[8:11], s38 offen nt lds
    s_add_u32 m0, s60, 0
    s_add_u32 s38, s44, 8192
    buffer_load_dwordx4 v227, s[8:11], s38 offen nt lds
    s_add_u32 m0, s60, 16896
    s_add_u32 s38, s44, 0
    buffer_load_dwordx4 v227, s[12:15], s38 offen nt lds
    s_add_u32 m0, s60, 8448
    s_add_u32 s38, s44, 16384
    buffer_load_dwordx4 v227, s[8:11], s38 offen nt lds
    s_add_u32 m0, s60, 25344
    s_add_u32 s38, s44, 8192
    buffer_load_dwordx4 v227, s[12:15], s38 offen nt lds
    s_add_u32 m0, s60, 33792
    s_add_u32 s38, s44, 24576
    buffer_load_dwordx4 v227, s[8:11], s38 offen nt lds
    s_add_u32 m0, s60, 50688
    s_add_u32 s38, s44, 16384
    buffer_load_dwordx4 v227, s[12:15], s38 offen nt lds
    s_add_u32 m0, s60, 42240
    s_add_u32 s38, s44, 32768
    buffer_load_dwordx4 v227, s[8:11], s38 offen nt lds
    s_add_u32 m0, s60, 59136
    s_add_u32 s38, s44, 24576
    buffer_load_dwordx4 v227, s[12:15], s38 offen nt lds
L_p_nby4:
    v_mfma_f32_16x16x32_bf16 v[108:111], v[184:187], v[192:195], v[108:111]
    ds_read_b128 v[160:163], v150 offset:0
    v_mfma_f32_16x16x32_bf16 v[112:115], v[184:187], v[196:199], v[112:115]
    ds_read_b128 v[164:167], v150 offset:2048
    v_mfma_f32_16x16x32_bf16 v[116:119], v[184:187], v[200:203], v[116:119]
    ds_read_b128 v[168:171], v150 offset:4096
    v_mfma_f32_16x16x32_bf16 v[120:123], v[184:187], v[204:207], v[120:123]
    ds_read_b128 v[172:175], v150 offset:6144
    v_mfma_f32_16x16x32_bf16 v[124:127], v[184:187], v[208:211], v[124:127]
    ds_read_b128 v[176:179], v150 offset:8192
    v_mfma_f32_16x16x32_bf16 v[128:131], v[188:191], v[192:195], v[128:131]
    ds_read_b64_tr_b16 v[152:153], v148 offset:32768
    v_mfma_f32_16x16x32_bf16 v[132:135], v[188:191], v[196:199], v[132:135]
    ds_read_b64_tr_b16 v[154:155], v148 offset:34816
    v_mfma_f32_16x16x32_bf16 v[136:139], v[188:191], v[200:203], v[136:139]
    ds_read_b64_tr_b16 v[156:157], v149 offset:32768
    v_mfma_f32_16x16x32_bf16 v[140:143], v[188:191], v[204:207], v[140:143]
    ds_read_b64_tr_b16 v[158:159], v149 offset:34816
    v_mfma_f32_16x16x32_bf16 v[144:147], v[188:191], v[208:211], v[144:147]
    s_add_u32 m0, s44, 144384
    s_nop 0
    buffer_load_dwordx4 v255, s[16:19], s54 offen lds
    s_add_u32 m0, s43, 101376
    s_nop 0
    buffer_load_dwordx4 v253, s[20:23], s42 offen lds
    s_add_u32 m0, s43, 102400
    s_nop 0
    buffer_load_dwordx4 v254, s[20:23], s42 offen lds
    s_waitcnt vmcnt(3) lgkmcnt(0)
    s_barrier
    v_mfma_f32_16x16x32_bf16 v[108:111], v[152:155], v[160:163], v[108:111]
    ds_read_b128 v[192:195], v151 offset:0
    v_mfma_f32_16x16x32_bf16 v[112:115], v[152:155], v[164:167], v[112:115]
    ds_read_b128 v[196:199], v151 offset:2048
    v_mfma_f32_16x16x32_bf16 v[116:119], v[152:155], v[168:171], v[116:119]
    ds_read_b128 v[200:203], v151 offset:4096
    v_mfma_f32_16x16x32_bf16 v[120:123], v[152:155], v[172:175], v[120:123]
    ds_read_b128 v[204:207], v151 offset:6144
    v_mfma_f32_16x16x32_bf16 v[124:127], v[152:155], v[176:179], v[124:127]
    ds_read_b128 v[208:211], v151 offset:8192
    v_mfma_f32_16x16x32_bf16 v[128:131], v[156:159], v[160:163], v[128:131]
    ds_read_b64_tr_b16 v[184:185], v148 offset:0
    v_mfma_f32_16x16x32_bf16 v[132:135], v[156:159], v[164:167], v[132:135]
    ds_read_b64_tr_b16 v[186:187], v148 offset:2048
    v_mfma_f32_16x16x32_bf16 v[136:139], v[156:159], v[168:171], v[136:139]
    ds_read_b64_tr_b16 v[188:189], v149 offset:0
    v_mfma_f32_16x16x32_bf16 v[140:143], v[156:159], v[172:175], v[140:143]
    ds_read_b64_tr_b16 v[190:191], v149 offset:2048
    v_mfma_f32_16x16x32_bf16 v[144:147], v[156:159], v[176:179], v[144:147]
    s_add_u32 m0, s43, 117760
    s_nop 0
    buffer_load_dwordx4 v214, s[20:23], s42 offen lds
    s_add_u32 m0, s43, 118784
    s_nop 0
    buffer_load_dwordx4 v215, s[20:23], s42 offen lds
    s_add_u32 s57, s57, 1
    s_cmp_eq_u32 s57, 9
    s_cselect_b32 s57, 0, s57
    s_lshl_b32 s42, s57, 19
    s_lshl_b32 s54, s57, 7
    s_add_u32 s42, s42, s55
    s_add_u32 s54, s54, s45
    s_waitcnt vmcnt(2) lgkmcnt(0)
    s_barrier
    v_mfma_f32_16x16x32_bf16 v[108:111], v[184:187], v[192:195], v[108:111]
    ds_read_b128 v[160:163], v150 offset:10240
    v_mfma_f32_16x16x32_bf16 v[112:115], v[184:187], v[196:199], v[112:115]
    ds_read_b128 v[164:167], v150 offset:12288
    v_mfma_f32_16x16x32_bf16 v[116:119], v[184:187], v[200:203], v[116:119]
    ds_read_b128 v[168:171], v150 offset:14336
    v_mfma_f32_16x16x32_bf16 v[120:123], v[184:187], v[204:207], v[120:123]
    ds_read_b128 v[172:175], v150 offset:16384
    v_mfma_f32_16x16x32_bf16 v[124:127], v[184:187], v[208:211], v[124:127]
    ds_read_b128 v[176:179], v150 offset:18432
    v_mfma_f32_16x16x32_bf16 v[128:131], v[188:191], v[192:195], v[128:131]
    ds_read_b64_tr_b16 v[152:153], v148 offset:16384
    v_mfma_f32_16x16x32_bf16 v[132:135], v[188:191], v[196:199], v[132:135]
    ds_read_b64_tr_b16 v[154:155], v148 offset:18432
    v_mfma_f32_16x16x32_bf16 v[136:139], v[188:191], v[200:203], v[136:139]
    ds_read_b64_tr_b16 v[156:157], v149 offset:16384
    v_mfma_f32_16x16x32_bf16 v[140:143], v[188:191], v[204:207], v[140:143]
    ds_read_b64_tr_b16 v[158:159], v149 offset:18432
    v_mfma_f32_16x16x32_bf16 v[144:147], v[188:191], v[208:211], v[144:147]
    s_add_u32 m0, s44, 134144
    s_nop 0
    buffer_load_dwordx4 v255, s[16:19], s54 offen lds
    s_add_u32 m0, s43, 84992
    s_nop 0
    buffer_load_dwordx4 v253, s[20:23], s42 offen lds
    s_add_u32 m0, s43, 86016
    s_nop 0
    buffer_load_dwordx4 v254, s[20:23], s42 offen lds
    s_waitcnt vmcnt(3) lgkmcnt(0)
    s_barrier
    v_mfma_f32_16x16x32_bf16 v[108:111], v[152:155], v[160:163], v[108:111]
    ds_read_b128 v[192:195], v151 offset:10240
    v_mfma_f32_16x16x32_bf16 v[112:115], v[152:155], v[164:167], v[112:115]
    ds_read_b128 v[196:199], v151 offset:12288
    v_mfma_f32_16x16x32_bf16 v[116:119], v[152:155], v[168:171], v[116:119]
    ds_read_b128 v[200:203], v151 offset:14336
    v_mfma_f32_16x16x32_bf16 v[120:123], v[152:155], v[172:175], v[120:123]
    ds_read_b128 v[204:207], v151 offset:16384
    v_mfma_f32_16x16x32_bf16 v[124:127], v[152:155], v[176:179], v[124:127]
    ds_read_b128 v[208:211], v151 offset:18432
    v_mfma_f32_16x16x32_bf16 v[128:131], v[156:159], v[160:163], v[128:131]
    ds_read_b64_tr_b16 v[184:185], v148 offset:32768
    v_mfma_f32_16x16x32_bf16 v[132:135], v[156:159], v[164:167], v[132:135]
    ds_read_b64_tr_b16 v[186:187], v148 offset:34816
    v_mfma_f32_16x16x32_bf16 v[136:139], v[156:159], v[168:171], v[136:139]
    ds_read_b64_tr_b16 v[188:189], v149 offset:32768
    v_mfma_f32_16x16x32_bf16 v[140:143], v[156:159], v[172:175], v[140:143]
    ds_read_b64_tr_b16 v[190:191], v149 offset:34816
    v_mfma_f32_16x16x32_bf16 v[144:147], v[156:159], v[176:179], v[144:147]
    s_add_u32 m0, s43, 101376
    s_nop 0
    buffer_load_dwordx4 v214, s[20:23], s42 offen lds
    s_add_u32 m0, s43, 102400
    s_nop 0
    buffer_load_dwordx4 v215, s[20:23], s42 offen lds
    s_add_u32 s57, s57, 1
    s_cmp_eq_u32 s57, 9
    s_cselect_b32 s57, 0, s57
    s_lshl_b32 s42, s57, 19
    s_lshl_b32 s54, s57, 7
    s_add_u32 s42, s42, s55
    s_add_u32 s54, s54, s45
    s_waitcnt vmcnt(2) lgkmcnt(0)
    s_barrier
    s_cmp_lg_u32 s47, 4
    s_cbranch_scc1 L_p_nby8
    s_add_u32 m0, s60, 155392
    s_add_u32 s38, s44, 0
    buffer_load_dwordx4 v227, s[8:11], s38 offen nt lds
    s_add_u32 m0, s60, 0
    s_add_u32 s38, s44, 8192
    buffer_load_dwordx4 v227, s[8:11], s38 offen nt lds
    s_add_u32 m0, s60, 16896
    s_add_u32 s38, s44, 0
    buffer_load_dwordx4 v227, s[12:15], s38 offen nt lds
    s_add_u32 m0, s60, 8448
    s_add_u32 s38, s44, 16384
    buffer_load_dwordx4 v227, s[8:11], s38 offen nt lds
    s_add_u32 m0, s60, 25344
    s_add_u32 s38, s44, 8192
    buffer_load_dwordx4 v227, s[12:15], s38 offen nt lds
    s_add_u32 m0, s60, 33792
    s_add_u32 s38, s44, 24576
    buffer_load_dwordx4 v227, s[8:11], s38 offen nt lds
    s_add_u32 m0, s60, 50688
    s_add_u32 s38, s44, 16384
    buffer_load_dwordx4 v227, s[12:15], s38 offen nt lds
    s_add_u32 m0, s60, 42240
    s_add_u32 s38, s44, 32768
    buffer_load_dwordx4 v227, s[8:11], s38 offen nt lds
    s_add_u32 m0, s60, 59136
    s_add_u32 s38, s44, 24576
    buffer_load_dwordx4 v227, s[12:15], s38 offen nt lds
L_p_nby8:
    v_mfma_f32_16x16x32_bf16 v[108:111], v[184:187], v[192:195], v[108:111]
    ds_read_b128 v[160:163], v150 offset:0
    v_mfma_f32_16x16x32_bf16 v[112:115], v[184:187], v[196:199], v[112:115]
    ds_read_b128 v[164:167], v150 offset:2048
    v_mfma_f32_16x16x32_bf16 v[116:119], v[184:187], v[200:203], v[116:119]
    ds_read_b128 v[168:171], v150 offset:4096
    v_mfma_f32_16x16x32_bf16 v[120:123], v[184:187], v[204:207], v[120:123]
    ds_read_b128 v[172:175], v150 offset:6144
    v_mfma_f32_16x16x32_bf16 v[124:127], v[184:187], v[208:211], v[124:127]
    ds_read_b128 v[176:179], v150 offset:8192
    v_mfma_f32_16x16x32_bf16 v[128:131], v[188:191], v[192:195], v[128:131]
    ds_read_b64_tr_b16 v[152:153], v148 offset:0
    v_mfma_f32_16x16x32_bf16 v[132:135], v[188:191], v[196:199], v[132:135]
    ds_read_b64_tr_b16 v[154:155], v148 offset:2048
    v_mfma_f32_16x16x32_bf16 v[136:139], v[188:191], v[200:203], v[136:139]
    ds_read_b64_tr_b16 v[156:157], v149 offset:0
    v_mfma_f32_16x16x32_bf16 v[140:143], v[188:191], v[204:207], v[140:143]
    ds_read_b64_tr_b16 v[158:159], v149 offset:2048
    v_mfma_f32_16x16x32_bf16 v[144:147], v[188:191], v[208:211], v[144:147]
    s_add_u32 m0, s44, 144384
    s_nop 0
    buffer_load_dwordx4 v255, s[16:19], s54 offen lds
    s_add_u32 m0, s43, 117760
    s_nop 0
    buffer_load_dwordx4 v253, s[20:23], s42 offen lds
    s_add_u32 m0, s43, 118784
    s_nop 0
    buffer_load_dwordx4 v254, s[20:23], s42 offen lds
    s_waitcnt vmcnt(3) lgkmcnt(0)
    s_barrier
    v_mfma_f32_16x16x32_bf16 v[108:111], v[152:155], v[160:163], v[108:111]
    ds_read_b128 v[192:195], v151 offset:0
    v_mfma_f32_16x16x32_bf16 v[112:115], v[152:155], v[164:167], v[112:115]
    ds_read_b128 v[196:199], v151 offset:2048
    v_mfma_f32_16x16x32_bf16 v[116:119], v[152:155], v[168:171], v[116:119]
    ds_read_b128 v[200:203], v151 offset:4096
    v_mfma_f32_16x16x32_bf16 v[120:123], v[152:155], v[172:175], v[120:123]
    ds_read_b128 v[204:207], v151 offset:6144
    v_mfma_f32_16x16x32_bf16 v[124:127], v[152:155], v[176:179], v[124:127]
    ds_read_b128 v[208:211], v151 offset:8192
    v_mfma_f32_16x16x32_bf16 v[128:131], v[156:159], v[160:163], v[128:131]
    ds_read_b64_tr_b16 v[184:185], v148 offset:16384
    v_mfma_f32_16x16x32_bf16 v[132:135], v[156:159], v[164:167], v[132:135]
    ds_read_b64_tr_b16 v[186:187], v148 offset:18432
    v_mfma_f32_16x16x32_bf16 v[136:139], v[156:159], v[168:171], v[136:139]
    ds_read_b64_tr_b16 v[188:189], v149 offset:16384
    v_mfma_f32_16x16x32_bf16 v[140:143], v[156:159], v[172:175], v[140:143]
    ds_read_b64_tr_b16 v[190:191], v149 offset:18432
    v_mfma_f32_16x16x32_bf16 v[144:147], v[156:159], v[176:179], v[144:147]
    s_add_u32 m0, s43, 84992
    s_nop 0
    buffer_load_dwordx4 v214, s[20:23], s42 offen lds
    s_add_u32 m0, s43, 86016
    s_nop 0
    buffer_load_dwordx4 v215, s[20:23], s42 offen lds
    s_add_u32 s57, s57, 1
    s_cmp_eq_u32 s57, 9
    s_cselect_b32 s57, 0, s57
    s_lshl_b32 s42, s57, 19
    s_lshl_b32 s54, s57, 7
    s_add_u32 s42, s42, s55
    s_add_u32 s54, s54, s45
    s_waitcnt vmcnt(2) lgkmcnt(0)
    s_barrier
    v_mfma_f32_16x16x32_bf16 v[108:111], v[184:187], v[192:195], v[108:111]
    ds_read_b128 v[160:163], v150 offset:10240
    v_mfma_f32_16x16x32_bf16 v[112:115], v[184:187], v[196:199], v[112:115]
    ds_read_b128 v[164:167], v150 offset:12288
    v_mfma_f32_16x16x32_bf16 v[116:119], v[184:187], v[200:203], v[116:119]
    ds_read_b128 v[168:171], v150 offset:14336
    v_mfma_f32_16x16x32_bf16 v[120:123], v[184:187], v[204:207], v[120:123]
    ds_read_b128 v[172:175], v150 offset:16384
    v_mfma_f32_16x16x32_bf16 v[124:127], v[184:187], v[208:211], v[124:127]
    ds_read_b128 v[176:179], v150 offset:18432
    v_mfma_f32_16x16x32_bf16 v[128:131], v[188:191], v[192:195], v[128:131]
    ds_read_b64_tr_b16 v[152:153], v148 offset:32768
    v_mfma_f32_16x16x32_bf16 v[132:135], v[188:191], v[196:199], v[132:135]
    ds_read_b64_tr_b16 v[154:155], v148 offset:34816
    v_mfma_f32_16x16x32_bf16 v[136:139], v[188:191], v[200:203], v[136:139]
    ds_read_b64_tr_b16 v[156:157], v149 offset:32768
    v_mfma_f32_16x16x32_bf16 v[140:143], v[188:191], v[204:207], v[140:143]
    ds_read_b64_tr_b16 v[158:159], v149 offset:34816
    v_mfma_f32_16x16x32_bf16 v[144:147], v[188:191], v[208:211], v[144:147]
    s_add_u32 m0, s44, 134144
    s_nop 0
    buffer_load_dwordx4 v255, s[16:19], s54 offen lds
    s_add_u32 m0, s43, 101376
    s_nop 0
    buffer_load_dwordx4 v253, s[20:23], s42 offen lds
    s_add_u32 m0, s43, 102400
    s_nop 0
    buffer_load_dwordx4 v254, s[20:23], s42 offen lds
    s_waitcnt vmcnt(3) lgkmcnt(0)
    s_barrier
    v_mfma_f32_16x16x32_bf16 v[108:111], v[152:155], v[160:163], v[108:111]
    ds_read_b128 v[192:195], v151 offset:10240
    v_mfma_f32_16x16x32_bf16 v[112:115], v[152:155], v[164:167], v[112:115]
    ds_read_b128 v[196:199], v151 offset:12288
    v_mfma_f32_16x16x32_bf16 v[116:119], v[152:155], v[168:171], v[116:119]
    ds_read_b128 v[200:203], v151 offset:14336
    v_mfma_f32_16x16x32_bf16 v[120:123], v[152:155], v[172:175], v[120:123]
    ds_read_b128 v[204:207], v151 offset:16384
    v_mfma_f32_16x16x32_bf16 v[124:127], v[152:155], v[176:179], v[124:127]
    ds_read_b128 v[208:211], v151 offset:18432
    v_mfma_f32_16x16x32_bf16 v[128:131], v[156:159], v[160:163], v[128:131]
    ds_read_b64_tr_b16 v[184:185], v148 offset:0
    v_mfma_f32_16x16x32_bf16 v[132:135], v[156:159], v[164:167], v[132:135]
    ds_read_b64_tr_b16 v[186:187], v148 offset:2048
    v_mfma_f32_16x16x32_bf16 v[136:139], v[156:159], v[168:171], v[136:139]
    ds_read_b64_tr_b16 v[188:189], v149 offset:0
    v_mfma_f32_16x16x32_bf16 v[140:143], v[156:159], v[172:175], v[140:143]
    ds_read_b64_tr_b16 v[190:191], v149 offset:2048
    v_mfma_f32_16x16x32_bf16 v[144:147], v[156:159], v[176:179], v[144:147]
    s_add_u32 m0, s43, 117760
    s_nop 0
    buffer_load_dwordx4 v214, s[20:23], s42 offen lds
    s_add_u32 m0, s43, 118784
    s_nop 0
    buffer_load_dwordx4 v215, s[20:23], s42 offen lds
    s_add_u32 s57, s57, 1
    s_cmp_eq_u32 s57, 9
    s_cselect_b32 s57, 0, s57
    s_lshl_b32 s42, s57, 19
    s_lshl_b32 s54, s57, 7
    s_add_u32 s42, s42, s55
    s_add_u32 s54, s54, s45
    s_waitcnt vmcnt(2) lgkmcnt(0)
    s_barrier
    v_mfma_f32_16x16x32_bf16 v[108:111], v[184:187], v[192:195], v[108:111]
    ds_read_b128 v[160:163], v150 offset:0
    v_mfma_f32_16x16x32_bf16 v[112:115], v[184:187], v[196:199], v[112:115]
    ds_read_b128 v[164:167], v150 offset:2048
    v_mfma_f32_16x16x32_bf16 v[116:119], v[184:187], v[200:203], v[116:119]
    ds_read_b128 v[168:171], v150 offset:4096
    v_mfma_f32_16x16x32_bf16 v[120:123], v[184:187], v[204:207], v[120:123]
    ds_read_b128 v[172:175], v150 offset:6144
    v_mfma_f32_16x16x32_bf16 v[124:127], v[184:187], v[208:211], v[124:127]
    ds_read_b128 v[176:179], v150 offset:8192
    v_mfma_f32_16x16x32_bf16 v[128:131], v[188:191], v[192:195], v[128:131]
    ds_read_b64_tr_b16 v[152:153], v148 offset:16384
    v_mfma_f32_16x16x32_bf16 v[132:135], v[188:191], v[196:199], v[132:135]
    ds_read_b64_tr_b16 v[154:155], v148 offset:18432
    v_mfma_f32_16x16x32_bf16 v[136:139], v[188:191], v[200:203], v[136:139]
    ds_read_b64_tr_b16 v[156:157], v149 offset:16384
    v_mfma_f32_16x16x32_bf16 v[140:143], v[188:191], v[204:207], v[140:143]
    ds_read_b64_tr_b16 v[158:159], v149 offset:18432
    v_mfma_f32_16x16x32_bf16 v[144:147], v[188:191], v[208:211], v[144:147]
    s_add_u32 m0, s44, 144384
    s_nop 0
    buffer_load_dwordx4 v255, s[16:19], s54 offen lds
    s_add_u32 m0, s43, 84992
    s_nop 0
    buffer_load_dwordx4 v253, s[20:23], s42 offen lds
    s_add_u32 m0, s43, 86016
    s_nop 0
    buffer_load_dwordx4 v254, s[20:23], s42 offen lds
    s_waitcnt vmcnt(3) lgkmcnt(0)
    s_barrier
    v_mfma_f32_16x16x32_bf16 v[108:111], v[152:155], v[160:163], v[108:111]
    ds_read_b128 v[192:195], v151 offset:0
    v_mfma_f32_16x16x32_bf16 v[112:115], v[152:155], v[164:167], v[112:115]
    ds_read_b128 v[196:199], v151 offset:2048
    v_mfma_f32_16x16x32_bf16 v[116:119], v[152:155], v[168:171], v[116:119]
    ds_read_b128 v[200:203], v151 offset:4096
    v_mfma_f32_16x16x32_bf16 v[120:123], v[152:155], v[172:175], v[120:123]
    ds_read_b128 v[204:207], v151 offset:6144
    v_mfma_f32_16x16x32_bf16 v[124:127], v[152:155], v[176:179], v[124:127]
    ds_read_b128 v[208:211], v151 offset:8192
    v_mfma_f32_16x16x32_bf16 v[128:131], v[156:159], v[160:163], v[128:131]
    ds_read_b64_tr_b16 v[184:185], v148 offset:32768
    v_mfma_f32_16x16x32_bf16 v[132:135], v[156:159], v[164:167], v[132:135]
    ds_read_b64_tr_b16 v[186:187], v148 offset:34816
    v_mfma_f32_16x16x32_bf16 v[136:139], v[156:159], v[168:171], v[136:139]
    ds_read_b64_tr_b16 v[188:189], v149 offset:32768
    v_mfma_f32_16x16x32_bf16 v[140:143], v[156:159], v[172:175], v[140:143]
    ds_read_b64_tr_b16 v[190:191], v149 offset:34816
    v_mfma_f32_16x16x32_bf16 v[144:147], v[156:159], v[176:179], v[144:147]
    s_add_u32 m0, s43, 101376
    s_nop 0
    buffer_load_dwordx4 v214, s[20:23], s42 offen lds
    s_add_u32 m0, s43, 102400
    s_nop 0
    buffer_load_dwordx4 v215, s[20:23], s42 offen lds
    s_add_u32 s57, s57, 1
    s_cmp_eq_u32 s57, 9
    s_cselect_b32 s57, 0, s57
    s_lshl_b32 s42, s57, 19
    s_lshl_b32 s54, s57, 7
    s_add_u32 s42, s42, s55
    s_add_u32 s54, s54, s45
    s_waitcnt vmcnt(2) lgkmcnt(0)
    s_barrier
    v_mfma_f32_16x16x32_bf16 v[108:111], v[184:187], v[192:195], v[108:111]
    ds_read_b128 v[160:163], v150 offset:10240
    v_mfma_f32_16x16x32_bf16 v[112:115], v[184:187], v[196:199], v[112:115]
    ds_read_b128 v[164:167], v150 offset:12288
    v_mfma_f32_16x16x32_bf16 v[116:119], v[184:187], v[200:203], v[116:119]
    ds_read_b128 v[168:171], v150 offset:14336
    v_mfma_f32_16x16x32_bf16 v[120:123], v[184:187], v[204:207], v[120:123]
    ds_read_b128 v[172:175], v150 offset:16384
    v_mfma_f32_16x16x32_bf16 v[124:127], v[184:187], v[208:211], v[124:127]
    ds_read_b128 v[176:179], v150 offset:18432
    v_mfma_f32_16x16x32_bf16 v[128:131], v[188:191], v[192:195], v[128:131]
    ds_read_b64_tr_b16 v[152:153], v148 offset:0
    v_mfma_f32_16x16x32_bf16 v[132:135], v[188:191], v[196:199], v[132:135]
    ds_read_b64_tr_b16 v[154:155], v148 offset:2048
    v_mfma_f32_16x16x32_bf16 v[136:139], v[188:191], v[200:203], v[136:139]
    ds_read_b64_tr_b16 v[156:157], v149 offset:0
    v_mfma_f32_16x16x32_bf16 v[140:143], v[188:191], v[204:207], v[140:143]
    ds_read_b64_tr_b16 v[158:159], v149 offset:2048
    v_mfma_f32_16x16x32_bf16 v[144:147], v[188:191], v[208:211], v[144:147]
    s_add_u32 m0, s44, 134144
    s_nop 0
    buffer_load_dwordx4 v255, s[16:19], s54 offen lds
    s_add_u32 m0, s43, 117760
    s_nop 0
    buffer_load_dwordx4 v253, s[20:23], s42 offen lds
    s_add_u32 m0, s43, 118784
    s_nop 0
    buffer_load_dwordx4 v254, s[20:23], s42 offen lds
    s_waitcnt vmcnt(3) lgkmcnt(0)
    s_barrier
    v_mfma_f32_16x16x32_bf16 v[108:111], v[152:155], v[160:163], v[108:111]
    ds_read_b128 v[192:195], v151 offset:10240
    v_mfma_f32_16x16x32_bf16 v[112:115], v[152:155], v[164:167], v[112:115]
    ds_read_b128 v[196:199], v151 offset:12288
    v_mfma_f32_16x16x32_bf16 v[116:119], v[152:155], v[168:171], v[116:119]
    ds_read_b128 v[200:203], v151 offset:14336
    v_mfma_f32_16x16x32_bf16 v[120:123], v[152:155], v[172:175], v[120:123]
    ds_read_b128 v[204:207], v151 offset:16384
    v_mfma_f32_16x16x32_bf16 v[124:127], v[152:155], v[176:179], v[124:127]
    ds_read_b128 v[208:211], v151 offset:18432
    v_mfma_f32_16x16x32_bf16 v[128:131], v[156:159], v[160:163], v[128:131]
    ds_read_b64_tr_b16 v[184:185], v148 offset:16384
    v_mfma_f32_16x16x32_bf16 v[132:135], v[156:159], v[164:167], v[132:135]
    ds_read_b64_tr_b16 v[186:187], v148 offset:18432
    v_mfma_f32_16x16x32_bf16 v[136:139], v[156:159], v[168:171], v[136:139]
    ds_read_b64_tr_b16 v[188:189], v149 offset:16384
    v_mfma_f32_16x16x32_bf16 v[140:143], v[156:159], v[172:175], v[140:143]
    ds_read_b64_tr_b16 v[190:191], v149 offset:18432
    v_mfma_f32_16x16x32_bf16 v[144:147], v[156:159], v[176:179], v[144:147]
    s_add_u32 m0, s43, 84992
    s_nop 0
    buffer_load_dwordx4 v214, s[20:23], s42 offen lds
    s_add_u32 m0, s43, 86016
    s_nop 0
    buffer_load_dwordx4 v215, s[20:23], s42 offen lds
    s_waitcnt vmcnt(2) lgkmcnt(0)
    s_barrier
    v_mfma_f32_16x16x32_bf16 v[108:111], v[184:187], v[192:195], v[108:111]
    ds_read_b128 v[160:163], v150 offset:0
    v_mfma_f32_16x16x32_bf16 v[112:115], v[184:187], v[196:199], v[112:115]
    ds_read_b128 v[164:167], v150 offset:2048
    v_mfma_f32_16x16x32_bf16 v[116:119], v[184:187], v[200:203], v[116:119]
    ds_read_b128 v[168:171], v150 offset:4096
    v_mfma_f32_16x16x32_bf16 v[120:123], v[184:187], v[204:207], v[120:123]
    ds_read_b128 v[172:175], v150 offset:6144
    v_mfma_f32_16x16x32_bf16 v[124:127], v[184:187], v[208:211], v[124:127]
    ds_read_b128 v[176:179], v150 offset:8192
    v_mfma_f32_16x16x32_bf16 v[128:131], v[188:191], v[192:195], v[128:131]
    ds_read_b64_tr_b16 v[152:153], v148 offset:32768
    v_mfma_f32_16x16x32_bf16 v[132:135], v[188:191], v[196:199], v[132:135]
    ds_read_b64_tr_b16 v[154:155], v148 offset:34816
    v_mfma_f32_16x16x32_bf16 v[136:139], v[188:191], v[200:203], v[136:139]
    ds_read_b64_tr_b16 v[156:157], v149 offset:32768
    v_mfma_f32_16x16x32_bf16 v[140:143], v[188:191], v[204:207], v[140:143]
    ds_read_b64_tr_b16 v[158:159], v149 offset:34816
    v_mfma_f32_16x16x32_bf16 v[144:147], v[188:191], v[208:211], v[144:147]
    s_cmp_lg_u32 s47, 8
    s_cbranch_scc1 L_p_b1y
    s_add_u32 m0, s60, 155392
    s_add_u32 s38, s44, 0
    buffer_load_dwordx4 v227, s[8:11], s38 offen nt lds
    s_add_u32 m0, s60, 0
    s_add_u32 s38, s44, 8192
    buffer_load_dwordx4 v227, s[8:11], s38 offen nt lds
    s_add_u32 m0, s60, 16896
    s_add_u32 s38, s44, 0
    buffer_load_dwordx4 v227, s[12:15], s38 offen nt lds
    s_waitcnt vmcnt(3) lgkmcnt(0)
    s_branch L_p_b2y
L_p_b1y:
    s_bitcmp1_b32 s33, 0
    s_cbranch_scc1 L_p_b4y
    s_mul_i32 s39, s32, 9216
    s_and_b32 s38, s33, 7
    s_lshr_b32 s38, s38, 1
    s_mul_i32 s38, s38, 73728
    s_add_u32 s38, s38, s39
    s_and_b32 s39, s34, 1
    s_mul_i32 s39, s39, 294912
    s_add_u32 s38, s38, s39
    v_lshlrev_b32 v233, 7, v216
    v_and_b32 v234, 7, v216
    v_lshlrev_b32 v234, 7, v234
    v_add_u32 v234, 8192, v234
    buffer_load_dword v229, v233, s[24:27], s38 offen
    buffer_load_dword v229, v234, s[24:27], s38 offen
    s_waitcnt vmcnt(2) lgkmcnt(0)
    s_branch L_p_b2y
L_p_b4y:
    s_waitcnt vmcnt(0) lgkmcnt(0)
L_p_b2y:
    s_barrier
    v_mfma_f32_16x16x32_bf16 v[108:111], v[152:155], v[160:163], v[108:111]
    ds_read_b128 v[192:195], v151 offset:0
    v_mfma_f32_16x16x32_bf16 v[112:115], v[152:155], v[164:167], v[112:115]
    ds_read_b128 v[196:199], v151 offset:2048
    v_mfma_f32_16x16x32_bf16 v[116:119], v[152:155], v[168:171], v[116:119]
    ds_read_b128 v[200:203], v151 offset:4096
    v_mfma_f32_16x16x32_bf16 v[120:123], v[152:155], v[172:175], v[120:123]
    ds_read_b128 v[204:207], v151 offset:6144
    v_mfma_f32_16x16x32_bf16 v[124:127], v[152:155], v[176:179], v[124:127]
    ds_read_b128 v[208:211], v151 offset:8192
    v_mfma_f32_16x16x32_bf16 v[128:131], v[156:159], v[160:163], v[128:131]
    ds_read_b64_tr_b16 v[184:185], v148 offset:0
    v_mfma_f32_16x16x32_bf16 v[132:135], v[156:159], v[164:167], v[132:135]
    ds_read_b64_tr_b16 v[186:187], v148 offset:2048
    v_mfma_f32_16x16x32_bf16 v[136:139], v[156:159], v[168:171], v[136:139]
    ds_read_b64_tr_b16 v[188:189], v149 offset:0
    v_mfma_f32_16x16x32_bf16 v[140:143], v[156:159], v[172:175], v[140:143]
    ds_read_b64_tr_b16 v[190:191], v149 offset:2048
    v_mfma_f32_16x16x32_bf16 v[144:147], v[156:159], v[176:179], v[144:147]
L_p_fin:
    s_cmp_lg_u32 s47, 8
    s_cbranch_scc1 L_p_f2
    s_add_u32 m0, s60, 8448
    s_add_u32 s38, s44, 16384
    buffer_load_dwordx4 v227, s[8:11], s38 offen nt lds
    s_add_u32 m0, s60, 25344
    s_add_u32 s38, s44, 8192
    buffer_load_dwordx4 v227, s[12:15], s38 offen nt lds
L_p_f2:
    s_waitcnt lgkmcnt(0)
    v_mfma_f32_16x16x32_bf16 v[108:111], v[184:187], v[192:195], v[108:111]
    v_mfma_f32_16x16x32_bf16 v[112:115], v[184:187], v[196:199], v[112:115]
    v_mfma_f32_16x16x32_bf16 v[116:119], v[184:187], v[200:203], v[116:119]
    v_mfma_f32_16x16x32_bf16 v[120:123], v[184:187], v[204:207], v[120:123]
    v_mfma_f32_16x16x32_bf16 v[124:127], v[184:187], v[208:211], v[124:127]
    v_mfma_f32_16x16x32_bf16 v[128:131], v[188:191], v[192:195], v[128:131]
    v_mfma_f32_16x16x32_bf16 v[132:135], v[188:191], v[196:199], v[132:135]
    v_mfma_f32_16x16x32_bf16 v[136:139], v[188:191], v[200:203], v[136:139]
    v_mfma_f32_16x16x32_bf16 v[140:143], v[188:191], v[204:207], v[140:143]
    v_mfma_f32_16x16x32_bf16 v[144:147], v[188:191], v[208:211], v[144:147]
    v_pk_mul_f32 v[108:109], v[108:109], s[50:51]
    v_pk_mul_f32 v[110:111], v[110:111], s[50:51]
    v_cvt_pk_bf16_f32 v152, v108, v109
    v_cvt_pk_bf16_f32 v153, v110, v111
    ds_write_b64 v248, v[152:153] offset:0
    v_pk_mul_f32 v[112:113], v[112:113], s[50:51]
    v_pk_mul_f32 v[114:115], v[114:115], s[50:51]
    v_cvt_pk_bf16_f32 v154, v112, v113
    v_cvt_pk_bf16_f32 v155, v114, v115
    ds_write_b64 v248, v[154:155] offset:4096
    v_pk_mul_f32 v[116:117], v[116:117], s[50:51]
    v_pk_mul_f32 v[118:119], v[118:119], s[50:51]
    v_cvt_pk_bf16_f32 v156, v116, v117
    v_cvt_pk_bf16_f32 v157, v118, v119
    ds_write_b64 v248, v[156:157] offset:8192
    v_pk_mul_f32 v[120:121], v[120:121], s[50:51]
    v_pk_mul_f32 v[122:123], v[122:123], s[50:51]
    v_cvt_pk_bf16_f32 v158, v120, v121
    v_cvt_pk_bf16_f32 v159, v122, v123
    ds_write_b64 v248, v[158:159] offset:12288
    v_pk_mul_f32 v[124:125], v[124:125], s[50:51]
    v_pk_mul_f32 v[126:127], v[126:127], s[50:51]
    v_cvt_pk_bf16_f32 v160, v124, v125
    v_cvt_pk_bf16_f32 v161, v126, v127
    ds_write_b64 v250, v[160:161]
    v_pk_mul_f32 v[128:129], v[128:129], s[50:51]
    v_pk_mul_f32 v[130:131], v[130:131], s[50:51]
    v_cvt_pk_bf16_f32 v162, v128, v129
    v_cvt_pk_bf16_f32 v163, v130, v131
    ds_write_b64 v249, v[162:163] offset:0
    v_pk_mul_f32 v[132:133], v[132:133], s[50:51]
    v_pk_mul_f32 v[134:135], v[134:135], s[50:51]
    v_cvt_pk_bf16_f32 v164, v132, v133
    v_cvt_pk_bf16_f32 v165, v134, v135
    ds_write_b64 v249, v[164:165] offset:4096
    v_pk_mul_f32 v[136:137], v[136:137], s[50:51]
    v_pk_mul_f32 v[138:139], v[138:139], s[50:51]
    v_cvt_pk_bf16_f32 v166, v136, v137
    v_cvt_pk_bf16_f32 v167, v138, v139
    ds_write_b64 v249, v[166:167] offset:8192
    v_pk_mul_f32 v[140:141], v[140:141], s[50:51]
    v_pk_mul_f32 v[142:143], v[142:143], s[50:51]
    v_cvt_pk_bf16_f32 v168, v140, v141
    v_cvt_pk_bf16_f32 v169, v142, v143
    ds_write_b64 v249, v[168:169] offset:12288
    v_pk_mul_f32 v[144:145], v[144:145], s[50:51]
    v_pk_mul_f32 v[146:147], v[146:147], s[50:51]
    v_cvt_pk_bf16_f32 v170, v144, v145
    v_cvt_pk_bf16_f32 v171, v146, v147
    ds_write_b64 v251, v[170:171]
    s_cmp_lg_u32 s47, 8
    s_cbranch_scc1 L_p_b3
    s_add_u32 m0, s60, 33792
    s_add_u32 s38, s44, 24576
    buffer_load_dwordx4 v227, s[8:11], s38 offen nt lds
    s_add_u32 m0, s60, 50688
    s_add_u32 s38, s44, 16384
    buffer_load_dwordx4 v227, s[12:15], s38 offen nt lds
    s_add_u32 m0, s60, 42240
    s_add_u32 s38, s44, 32768
    buffer_load_dwordx4 v227, s[8:11], s38 offen nt lds
    s_add_u32 m0, s60, 59136
    s_add_u32 s38, s44, 24576
    buffer_load_dwordx4 v227, s[12:15], s38 offen nt lds
L_p_b3:
    s_waitcnt vmcnt(4) lgkmcnt(0)
    s_barrier
    ds_read_b128 v[64:67], v180 offset:0
    ds_read_b128 v[68:71], v181 offset:0
    ds_read_b128 v[72:75], v182 offset:0
    ds_read_b128 v[76:79], v183 offset:0
    ds_read_b128 v[80:83], v180 offset:4096
    ds_read_b128 v[84:87], v181 offset:4096
    ds_read_b128 v[88:91], v182 offset:4096
    ds_read_b128 v[92:95], v183 offset:4096
L_restart:
    ds_read_b128 v[152:155], v219 offset:0
    ds_read_b128 v[156:159], v219 offset:64
    ds_read_b128 v[160:163], v219 offset:128
    ds_read_b128 v[164:167], v219 offset:192
    ds_read_b128 v[168:171], v219 offset:512
    ds_read_b128 v[172:175], v219 offset:576
    ds_read_b128 v[176:179], v219 offset:640
    ds_read_b128 v[180:183], v219 offset:704
    s_mov_b32 s37, 0
    s_mov_b32 s36, 0
    s_cmp_ge_u32 s32, 4
    s_cbranch_scc1 L_helper
    s_waitcnt lgkmcnt(0)
    v_mfma_f32_16x16x32_bf16 v[112:115], v[152:155], v[64:67], 0
    v_mfma_f32_16x16x32_bf16 v[112:115], v[156:159], v[68:71], v[112:115]
    v_mfma_f32_16x16x32_bf16 v[112:115], v[160:163], v[72:75], v[112:115]
    v_mfma_f32_16x16x32_bf16 v[112:115], v[164:167], v[76:79], v[112:115]
    v_mfma_f32_16x16x32_bf16 v[120:123], v[152:155], v[80:83], 0
    v_mfma_f32_16x16x32_bf16 v[120:123], v[156:159], v[84:87], v[120:123]
    v_mfma_f32_16x16x32_bf16 v[120:123], v[160:163], v[88:91], v[120:123]
    v_mfma_f32_16x16x32_bf16 v[120:123], v[164:167], v[92:95], v[120:123]
    v_mfma_f32_16x16x32_bf16 v[116:119], v[168:171], v[64:67], 0
    v_mfma_f32_16x16x32_bf16 v[116:119], v[172:175], v[68:71], v[116:119]
    v_mfma_f32_16x16x32_bf16 v[116:119], v[176:179], v[72:75], v[116:119]
    v_mfma_f32_16x16x32_bf16 v[116:119], v[180:183], v[76:79], v[116:119]
    v_mfma_f32_16x16x32_bf16 v[124:127], v[168:171], v[80:83], 0
    v_mfma_f32_16x16x32_bf16 v[124:127], v[172:175], v[84:87], v[124:127]
    v_mfma_f32_16x16x32_bf16 v[124:127], v[176:179], v[88:91], v[124:127]
    v_mfma_f32_16x16x32_bf16 v[124:127], v[180:183], v[92:95], v[124:127]
    v_mov_b32 v219, v217
    v_mov_b32 v220, v218
    ds_read_b128 v[152:155], v219 offset:0
    ds_read_b128 v[156:159], v219 offset:64
    ds_read_b128 v[160:163], v219 offset:128
    ds_read_b128 v[164:167], v219 offset:192
    ds_read_b128 v[168:171], v219 offset:512
    ds_read_b128 v[172:175], v219 offset:576
    ds_read_b128 v[176:179], v219 offset:640
    ds_read_b128 v[180:183], v219 offset:704
    ds_read_b64_tr_b16 v[184:185], v220 offset:16896
    v_max3_f32 v230, v112, v113, v114
    v_max3_f32 v231, v120, v121, v122
    v_max3_f32 v230, v230, v115, v116
    v_max3_f32 v231, v231, v123, v124
    v_max3_f32 v230, v230, v117, v118
    v_max3_f32 v231, v231, v125, v126
    v_max_f32 v230, v230, v119
    v_max_f32 v231, v231, v127
    v_mov_b32 v232, v230
    v_mov_b32 v235, v231
    s_nop 0
    v_permlane16_swap_b32 v230, v232
    v_permlane16_swap_b32 v231, v235
    v_max_f32 v230, v230, v232
    v_max_f32 v231, v231, v235
    v_mov_b32 v232, v230
    v_mov_b32 v235, v231
    s_nop 0
    v_permlane32_swap_b32 v230, v232
    v_permlane32_swap_b32 v231, v235
    v_max_f32 v230, v230, v232
    v_max_f32 v231, v231, v235
    s_cmp_eq_u32 s61, 0
    s_cbranch_scc1 L_fmm
    v_mov_b32 v230, v106
    v_mov_b32 v231, v107
L_fmm:
    v_sub_f32 v96, 0, v230
    v_sub_f32 v97, 0, v230
    v_sub_f32 v98, 0, v230
    v_sub_f32 v99, 0, v230
    v_sub_f32 v100, 0, v231
    v_sub_f32 v101, 0, v231
    v_sub_f32 v102, 0, v231
    v_sub_f32 v103, 0, v231
    v_pk_add_f32 v[112:113], v[112:113], v[96:97]
    v_pk_add_f32 v[114:115], v[114:115], v[96:97]
    v_pk_add_f32 v[116:117], v[116:117], v[96:97]
    v_pk_add_f32 v[118:119], v[118:119], v[96:97]
    v_pk_add_f32 v[120:121], v[120:121], v[100:101]
    v_pk_add_f32 v[122:123], v[122:123], v[100:101]
    v_pk_add_f32 v[124:125], v[124:125], v[100:101]
    v_pk_add_f32 v[126:127], v[126:127], v[100:101]
    s_waitcnt lgkmcnt(0)
.p2align 3
L_m_loop:
    v_mfma_f32_16x16x32_bf16 v[128:131], v[152:155], v[64:67], v[96:99]
    v_exp_f32 v112, v112
    v_mfma_f32_16x16x32_bf16 v[128:131], v[156:159], v[68:71], v[128:131]
    v_exp_f32 v113, v113
    v_mfma_f32_16x16x32_bf16 v[128:131], v[160:163], v[72:75], v[128:131]
    ds_read_b64_tr_b16 v[186:187], v220 offset:17408
    ds_read_b64_tr_b16 v[188:189], v220 offset:16928
    ds_read_b64_tr_b16 v[190:191], v220 offset:17440
    v_cvt_pk_bf16_f32 v144, v112, v113
    v_mfma_f32_16x16x32_bf16 v[128:131], v[164:167], v[76:79], v[128:131]
    v_exp_f32 v114, v114
    v_mfma_f32_16x16x32_bf16 v[136:139], v[152:155], v[80:83], v[100:103]
    v_exp_f32 v115, v115
    v_mfma_f32_16x16x32_bf16 v[136:139], v[156:159], v[84:87], v[136:139]
    ds_read_b64_tr_b16 v[192:193], v220 offset:16960
    ds_read_b64_tr_b16 v[194:195], v220 offset:17472
    ds_read_b64_tr_b16 v[196:197], v220 offset:16992
    v_cvt_pk_bf16_f32 v145, v114, v115
    v_mfma_f32_16x16x32_bf16 v[136:139], v[160:163], v[88:91], v[136:139]
    v_exp_f32 v116, v116
    v_mfma_f32_16x16x32_bf16 v[136:139], v[164:167], v[92:95], v[136:139]
    v_exp_f32 v117, v117
    v_mfma_f32_16x16x32_bf16 v[132:135], v[168:171], v[64:67], v[96:99]
    ds_read_b64_tr_b16 v[198:199], v220 offset:17504
    ds_read_b64_tr_b16 v[200:201], v220 offset:17024
    ds_read_b64_tr_b16 v[202:203], v220 offset:17536
    v_cvt_pk_bf16_f32 v146, v116, v117
    v_mfma_f32_16x16x32_bf16 v[132:135], v[172:175], v[68:71], v[132:135]
    s_waitcnt lgkmcnt(9)
    v_exp_f32 v118, v118
    v_mfma_f32_16x16x32_bf16 v[132:135], v[176:179], v[72:75], v[132:135]
    v_exp_f32 v119, v119
    v_mfma_f32_16x16x32_bf16 v[132:135], v[180:183], v[76:79], v[132:135]
    ds_read_b64_tr_b16 v[204:205], v220 offset:17056
    ds_read_b64_tr_b16 v[206:207], v220 offset:17568
    ds_read_b64_tr_b16 v[208:209], v220 offset:17088
    v_cvt_pk_bf16_f32 v147, v118, v119
    v_mfma_f32_16x16x32_bf16 v[140:143], v[168:171], v[80:83], v[100:103]
    v_exp_f32 v120, v120
    v_mfma_f32_16x16x32_bf16 v[140:143], v[172:175], v[84:87], v[140:143]
    v_exp_f32 v121, v121
    v_mfma_f32_16x16x32_bf16 v[140:143], v[176:179], v[88:91], v[140:143]
    ds_read_b64_tr_b16 v[210:211], v220 offset:17600
    ds_read_b64_tr_b16 v[212:213], v220 offset:17120
    ds_read_b64_tr_b16 v[214:215], v220 offset:17632
    v_cvt_pk_bf16_f32 v148, v120, v121
    v_mfma_f32_16x16x32_bf16 v[140:143], v[180:183], v[92:95], v[140:143]
    s_waitcnt lgkmcnt(6)
    v_exp_f32 v122, v122
    v_mfma_f32_16x16x32_bf16 v[0:3], v[184:187], v[144:147], v[0:3]
    s_add_u32 s37, s37, 33792
    v_exp_f32 v123, v123
    v_mfma_f32_16x16x32_bf16 v[4:7], v[188:191], v[144:147], v[4:7]
    s_cmp_eq_u32 s37, 135168
    v_exp_f32 v124, v124
    v_mfma_f32_16x16x32_bf16 v[16:19], v[192:195], v[144:147], v[16:19]
    s_cselect_b32 s37, 0, s37
    v_exp_f32 v125, v125
    v_mfma_f32_16x16x32_bf16 v[20:23], v[196:199], v[144:147], v[20:23]
    s_add_u32 s36, s36, 1
    v_exp_f32 v126, v126
    v_mfma_f32_16x16x32_bf16 v[32:35], v[200:203], v[144:147], v[32:35]
    s_waitcnt lgkmcnt(0)
    v_exp_f32 v127, v127
    v_mfma_f32_16x16x32_bf16 v[36:39], v[204:207], v[144:147], v[36:39]
    v_cvt_pk_bf16_f32 v149, v122, v123
    v_cvt_pk_bf16_f32 v150, v124, v125
    v_mfma_f32_16x16x32_bf16 v[48:51], v[208:211], v[144:147], v[48:51]
    v_cvt_pk_bf16_f32 v151, v126, v127
    v_add_f32 v224, v224, v112
    v_mfma_f32_16x16x32_bf16 v[52:55], v[212:215], v[144:147], v[52:55]
    v_add_f32 v225, v225, v113
    v_add_f32 v224, v224, v114
    v_mfma_f32_16x16x32_bf16 v[8:11], v[184:187], v[148:151], v[8:11]
    ds_read_b128 v[152:155], v219 offset:8448
    ds_read_b128 v[156:159], v219 offset:8512
    ds_read_b128 v[160:163], v219 offset:8576
    v_add_f32 v225, v225, v115
    v_mfma_f32_16x16x32_bf16 v[12:15], v[188:191], v[148:151], v[12:15]
    v_add_f32 v224, v224, v116
    v_add_f32 v225, v225, v117
    v_mfma_f32_16x16x32_bf16 v[24:27], v[192:195], v[148:151], v[24:27]
    v_add_f32 v224, v224, v118
    v_add_f32 v225, v225, v119
    v_mfma_f32_16x16x32_bf16 v[28:31], v[196:199], v[148:151], v[28:31]
    ds_read_b128 v[164:167], v219 offset:8640
    ds_read_b128 v[168:171], v219 offset:8960
    ds_read_b128 v[172:175], v219 offset:9024
    v_add_f32 v104, v104, v120
    v_mfma_f32_16x16x32_bf16 v[40:43], v[200:203], v[148:151], v[40:43]
    v_add_f32 v105, v105, v121
    v_add_f32 v104, v104, v122
    v_mfma_f32_16x16x32_bf16 v[44:47], v[204:207], v[148:151], v[44:47]
    v_add_f32 v105, v105, v123
    v_add_f32 v104, v104, v124
    v_mfma_f32_16x16x32_bf16 v[56:59], v[208:211], v[148:151], v[56:59]
    ds_read_b128 v[176:179], v219 offset:9088
    ds_read_b128 v[180:183], v219 offset:9152
    ds_read_b64_tr_b16 v[184:185], v220 offset:25344
    v_add_f32 v105, v105, v125
    v_mfma_f32_16x16x32_bf16 v[60:63], v[212:215], v[148:151], v[60:63]
    s_waitcnt lgkmcnt(3)
    v_add_f32 v104, v104, v126
    v_add_f32 v105, v105, v127
    v_mfma_f32_16x16x32_bf16 v[112:115], v[152:155], v[64:67], v[96:99]
    v_exp_f32 v128, v128
    v_mfma_f32_16x16x32_bf16 v[112:115], v[156:159], v[68:71], v[112:115]
    v_exp_f32 v129, v129
    v_mfma_f32_16x16x32_bf16 v[112:115], v[160:163], v[72:75], v[112:115]
    ds_read_b64_tr_b16 v[186:187], v220 offset:25856
    ds_read_b64_tr_b16 v[188:189], v220 offset:25376
    ds_read_b64_tr_b16 v[190:191], v220 offset:25888
    v_cvt_pk_bf16_f32 v144, v128, v129
    v_mfma_f32_16x16x32_bf16 v[112:115], v[164:167], v[76:79], v[112:115]
    v_exp_f32 v130, v130
    v_mfma_f32_16x16x32_bf16 v[120:123], v[152:155], v[80:83], v[100:103]
    v_exp_f32 v131, v131
    v_mfma_f32_16x16x32_bf16 v[120:123], v[156:159], v[84:87], v[120:123]
    ds_read_b64_tr_b16 v[192:193], v220 offset:25408
    ds_read_b64_tr_b16 v[194:195], v220 offset:25920
    ds_read_b64_tr_b16 v[196:197], v220 offset:25440
    v_cvt_pk_bf16_f32 v145, v130, v131
    v_mfma_f32_16x16x32_bf16 v[120:123], v[160:163], v[88:91], v[120:123]
    v_exp_f32 v132, v132
    v_mfma_f32_16x16x32_bf16 v[120:123], v[164:167], v[92:95], v[120:123]
    v_exp_f32 v133, v133
    v_mfma_f32_16x16x32_bf16 v[116:119], v[168:171], v[64:67], v[96:99]
    ds_read_b64_tr_b16 v[198:199], v220 offset:25952
    ds_read_b64_tr_b16 v[200:201], v220 offset:25472
    ds_read_b64_tr_b16 v[202:203], v220 offset:25984
    v_cvt_pk_bf16_f32 v146, v132, v133
    v_mfma_f32_16x16x32_bf16 v[116:119], v[172:175], v[68:71], v[116:119]
    s_waitcnt lgkmcnt(9)
    v_exp_f32 v134, v134
    v_mfma_f32_16x16x32_bf16 v[116:119], v[176:179], v[72:75], v[116:119]
    v_exp_f32 v135, v135
    v_mfma_f32_16x16x32_bf16 v[116:119], v[180:183], v[76:79], v[116:119]
    ds_read_b64_tr_b16 v[204:205], v220 offset:25504
    ds_read_b64_tr_b16 v[206:207], v220 offset:26016
    ds_read_b64_tr_b16 v[208:209], v220 offset:25536
    v_cvt_pk_bf16_f32 v147, v134, v135
    v_mfma_f32_16x16x32_bf16 v[124:127], v[168:171], v[80:83], v[100:103]
    v_exp_f32 v136, v136
    v_mfma_f32_16x16x32_bf16 v[124:127], v[172:175], v[84:87], v[124:127]
    v_exp_f32 v137, v137
    v_mfma_f32_16x16x32_bf16 v[124:127], v[176:179], v[88:91], v[124:127]
    ds_read_b64_tr_b16 v[210:211], v220 offset:26048
    ds_read_b64_tr_b16 v[212:213], v220 offset:25568
    ds_read_b64_tr_b16 v[214:215], v220 offset:26080
    v_cvt_pk_bf16_f32 v148, v136, v137
    v_mfma_f32_16x16x32_bf16 v[124:127], v[180:183], v[92:95], v[124:127]
    s_waitcnt lgkmcnt(6)
    v_exp_f32 v138, v138
    v_mfma_f32_16x16x32_bf16 v[0:3], v[184:187], v[144:147], v[0:3]
    s_cmp_lt_u32 s36, 16
    v_exp_f32 v139, v139
    v_mfma_f32_16x16x32_bf16 v[4:7], v[188:191], v[144:147], v[4:7]
    v_exp_f32 v140, v140
    v_mfma_f32_16x16x32_bf16 v[16:19], v[192:195], v[144:147], v[16:19]
    v_exp_f32 v141, v141
    v_mfma_f32_16x16x32_bf16 v[20:23], v[196:199], v[144:147], v[20:23]
    v_exp_f32 v142, v142
    v_mfma_f32_16x16x32_bf16 v[32:35], v[200:203], v[144:147], v[32:35]
    s_waitcnt vmcnt(0) lgkmcnt(0)
    v_exp_f32 v143, v143
    v_mfma_f32_16x16x32_bf16 v[36:39], v[204:207], v[144:147], v[36:39]
    v_cvt_pk_bf16_f32 v149, v138, v139
    v_cvt_pk_bf16_f32 v150, v140, v141
    v_mfma_f32_16x16x32_bf16 v[48:51], v[208:211], v[144:147], v[48:51]
    v_cvt_pk_bf16_f32 v151, v142, v143
    v_add_f32 v224, v224, v128
    v_mfma_f32_16x16x32_bf16 v[52:55], v[212:215], v[144:147], v[52:55]
    v_add_f32 v225, v225, v129
    v_add_f32 v224, v224, v130
    v_add_u32 v219, s37, v217
    v_mfma_f32_16x16x32_bf16 v[8:11], v[184:187], v[148:151], v[8:11]
    s_barrier
    ds_read_b128 v[152:155], v219 offset:0
    ds_read_b128 v[156:159], v219 offset:64
    ds_read_b128 v[160:163], v219 offset:128
    v_add_f32 v225, v225, v131
    v_mfma_f32_16x16x32_bf16 v[12:15], v[188:191], v[148:151], v[12:15]
    v_add_f32 v224, v224, v132
    v_add_f32 v225, v225, v133
    v_mfma_f32_16x16x32_bf16 v[24:27], v[192:195], v[148:151], v[24:27]
    v_add_f32 v224, v224, v134
    v_add_f32 v225, v225, v135
    v_mfma_f32_16x16x32_bf16 v[28:31], v[196:199], v[148:151], v[28:31]
    ds_read_b128 v[164:167], v219 offset:192
    ds_read_b128 v[168:171], v219 offset:512
    ds_read_b128 v[172:175], v219 offset:576
    v_add_f32 v104, v104, v136
    v_mfma_f32_16x16x32_bf16 v[40:43], v[200:203], v[148:151], v[40:43]
    v_add_f32 v105, v105, v137
    v_add_f32 v104, v104, v138
    v_add_u32 v220, s37, v218
    v_mfma_f32_16x16x32_bf16 v[44:47], v[204:207], v[148:151], v[44:47]
    v_add_f32 v105, v105, v139
    v_add_f32 v104, v104, v140
    v_mfma_f32_16x16x32_bf16 v[56:59], v[208:211], v[148:151], v[56:59]
    ds_read_b128 v[176:179], v219 offset:640
    ds_read_b128 v[180:183], v219 offset:704
    ds_read_b64_tr_b16 v[184:185], v220 offset:16896
    v_add_f32 v105, v105, v141
    v_mfma_f32_16x16x32_bf16 v[60:63], v[212:215], v[148:151], v[60:63]
    s_waitcnt lgkmcnt(3)
    v_add_f32 v104, v104, v142
    v_add_f32 v105, v105, v143
    s_cbranch_scc1 L_m_loop
    v_add_f32 v224, v224, v225
    v_add_f32 v104, v104, v105
    v_mov_b32 v225, v224
    v_mov_b32 v105, v104
    s_nop 0
    v_permlane16_swap_b32 v224, v225
    v_permlane16_swap_b32 v104, v105
    v_add_f32 v224, v224, v225
    v_add_f32 v104, v104, v105
    v_mov_b32 v225, v224
    v_mov_b32 v105, v104
    s_nop 0
    v_permlane32_swap_b32 v224, v225
    v_permlane32_swap_b32 v104, v105
    v_add_f32 v224, v224, v225
    v_add_f32 v104, v104, v105
    v_rcp_f32 v230, v224
    v_rcp_f32 v232, v104
    v_add_f32 v235, v224, v104
    v_cmp_nge_f32 vcc, s53, v235
    s_lshl_b32 s38, s32, 2
    s_add_u32 s38, s38, 140288
    v_mov_b32 v234, s38
    s_or_b32 s38, vcc_lo, vcc_hi
    v_mov_b32 v235, s38
    ds_write_b32 v234, v235
    v_mov_b32 v231, v230
    v_mov_b32 v233, v232
    v_subrev_u32 v226, 24576, v241
    v_pk_mul_f32 v[0:1], v[0:1], v[230:231]
    v_pk_mul_f32 v[2:3], v[2:3], v[230:231]
    v_pk_mul_f32 v[4:5], v[4:5], v[230:231]
    v_pk_mul_f32 v[6:7], v[6:7], v[230:231]
    s_waitcnt lgkmcnt(0)
    s_movk_i32 s39, 0
    v_cvt_pk_bf16_f32 v152, v0, v1
    v_cvt_pk_bf16_f32 v153, v2, v3
    v_cvt_pk_bf16_f32 v154, v4, v5
    v_cvt_pk_bf16_f32 v155, v6, v7
    ds_write_b128 v241, v[152:155] offset:0
    buffer_store_dwordx4 v[152:155], v226, s[28:31], s39 offen sc1
    v_pk_mul_f32 v[16:17], v[16:17], v[230:231]
    v_pk_mul_f32 v[18:19], v[18:19], v[230:231]
    v_pk_mul_f32 v[20:21], v[20:21], v[230:231]
    v_pk_mul_f32 v[22:23], v[22:23], v[230:231]
    s_movk_i32 s39, 5120
    v_cvt_pk_bf16_f32 v156, v16, v17
    v_cvt_pk_bf16_f32 v157, v18, v19
    v_cvt_pk_bf16_f32 v158, v20, v21
    v_cvt_pk_bf16_f32 v159, v22, v23
    ds_write_b128 v241, v[156:159] offset:5120
    buffer_store_dwordx4 v[156:159], v226, s[28:31], s39 offen sc1
    v_pk_mul_f32 v[32:33], v[32:33], v[230:231]
    v_pk_mul_f32 v[34:35], v[34:35], v[230:231]
    v_pk_mul_f32 v[36:37], v[36:37], v[230:231]
    v_pk_mul_f32 v[38:39], v[38:39], v[230:231]
    s_movk_i32 s39, 10240
    v_cvt_pk_bf16_f32 v160, v32, v33
    v_cvt_pk_bf16_f32 v161, v34, v35
    v_cvt_pk_bf16_f32 v162, v36, v37
    v_cvt_pk_bf16_f32 v163, v38, v39
    ds_write_b128 v241, v[160:163] offset:10240
    buffer_store_dwordx4 v[160:163], v226, s[28:31], s39 offen sc1
    v_pk_mul_f32 v[48:49], v[48:49], v[230:231]
    v_pk_mul_f32 v[50:51], v[50:51], v[230:231]
    v_pk_mul_f32 v[52:53], v[52:53], v[230:231]
    v_pk_mul_f32 v[54:55], v[54:55], v[230:231]
    s_movk_i32 s39, 15360
    v_cvt_pk_bf16_f32 v164, v48, v49
    v_cvt_pk_bf16_f32 v165, v50, v51
    v_cvt_pk_bf16_f32 v166, v52, v53
    v_cvt_pk_bf16_f32 v167, v54, v55
    ds_write_b128 v241, v[164:167] offset:15360
    buffer_store_dwordx4 v[164:167], v226, s[28:31], s39 offen sc1
    v_pk_mul_f32 v[8:9], v[8:9], v[232:233]
    v_pk_mul_f32 v[10:11], v[10:11], v[232:233]
    v_pk_mul_f32 v[12:13], v[12:13], v[232:233]
    v_pk_mul_f32 v[14:15], v[14:15], v[232:233]
    s_movk_i32 s39, 1024
    v_cvt_pk_bf16_f32 v168, v8, v9
    v_cvt_pk_bf16_f32 v169, v10, v11
    v_cvt_pk_bf16_f32 v170, v12, v13
    v_cvt_pk_bf16_f32 v171, v14, v15
    ds_write_b128 v241, v[168:171] offset:1024
    buffer_store_dwordx4 v[168:171], v226, s[28:31], s39 offen sc1
    v_pk_mul_f32 v[24:25], v[24:25], v[232:233]
    v_pk_mul_f32 v[26:27], v[26:27], v[232:233]
    v_pk_mul_f32 v[28:29], v[28:29], v[232:233]
    v_pk_mul_f32 v[30:31], v[30:31], v[232:233]
    s_movk_i32 s39, 6144
    v_cvt_pk_bf16_f32 v172, v24, v25
    v_cvt_pk_bf16_f32 v173, v26, v27
    v_cvt_pk_bf16_f32 v174, v28, v29
    v_cvt_pk_bf16_f32 v175, v30, v31
    ds_write_b128 v241, v[172:175] offset:6144
    buffer_store_dwordx4 v[172:175], v226, s[28:31], s39 offen sc1
    v_pk_mul_f32 v[40:41], v[40:41], v[232:233]
    v_pk_mul_f32 v[42:43], v[42:43], v[232:233]
    v_pk_mul_f32 v[44:45], v[44:45], v[232:233]
    v_pk_mul_f32 v[46:47], v[46:47], v[232:233]
    s_movk_i32 s39, 11264
    v_cvt_pk_bf16_f32 v176, v40, v41
    v_cvt_pk_bf16_f32 v177, v42, v43
    v_cvt_pk_bf16_f32 v178, v44, v45
    v_cvt_pk_bf16_f32 v179, v46, v47
    ds_write_b128 v241, v[176:179] offset:11264
    buffer_store_dwordx4 v[176:179], v226, s[28:31], s39 offen sc1
    v_pk_mul_f32 v[56:57], v[56:57], v[232:233]
    v_pk_mul_f32 v[58:59], v[58:59], v[232:233]
    v_pk_mul_f32 v[60:61], v[60:61], v[232:233]
    v_pk_mul_f32 v[62:63], v[62:63], v[232:233]
    s_movk_i32 s39, 16384
    v_cvt_pk_bf16_f32 v180, v56, v57
    v_cvt_pk_bf16_f32 v181, v58, v59
    v_cvt_pk_bf16_f32 v182, v60, v61
    v_cvt_pk_bf16_f32 v183, v62, v63
    ds_write_b128 v241, v[180:183] offset:16384
    buffer_store_dwordx4 v[180:183], v226, s[28:31], s39 offen sc1
    s_waitcnt lgkmcnt(0)
    s_barrier
    v_mov_b32 v234, 140288
    ds_read_b128 v[128:131], v234
    ds_read_b128 v[132:135], v234 offset:16
    s_cmp_ge_u32 s35, 2
    s_cselect_b32 s38, 3072, 0
    s_cselect_b32 s39, 2048, 0
    v_add_u32 v208, s38, v252
    v_subrev_u32 v209, s39, v252
    v_add_u32 v210, 10240, v208
    v_add_u32 v211, 10240, v209
    v_lshrrev_b32 v230, 2, v216
    v_lshlrev_b32 v230, 6, v230
    v_and_b32 v231, 3, v216
    v_lshl_add_u32 v230, v231, 3, v230
    v_bfe_u32 v231, v216, 4, 1
    s_and_b32 s38, s35, 1
    v_xor_b32 v231, s38, v231
    v_lshl_add_u32 v245, v231, 5, v230
    v_add_u32 v246, 36864, v245
    v_add_u32 v247, 126976, v245
    ds_read_b64_tr_b16 v[0:1], v236 offset:0
    ds_read_b64_tr_b16 v[2:3], v236 offset:2048
    ds_read_b64_tr_b16 v[4:5], v236 offset:4096
    ds_read_b64_tr_b16 v[6:7], v236 offset:6144
    ds_read_b64_tr_b16 v[8:9], v236 offset:8192
    ds_read_b64_tr_b16 v[10:11], v236 offset:10240
    ds_read_b64_tr_b16 v[12:13], v236 offset:12288
    ds_read_b64_tr_b16 v[14:15], v236 offset:14336
    ds_read_b64_tr_b16 v[16:17], v245 offset:16384
    ds_read_b64_tr_b16 v[18:19], v245 offset:17408
    v_mov_b32 v231, s46
    s_cmp_ge_u32 s35, 2
    s_cselect_b32 s38, 0x40000000, 0
    v_lshlrev_b32 v232, 3, v216
    v_or_b32 v232, s38, v232
    s_lshl_b32 s38, s35, 2
    s_and_b32 s39, s34, 1
    s_add_u32 s38, s38, s39
    s_lshl_b32 s38, s38, 8
    v_lshlrev_b32 v235, 9, v216
    v_add_u32 v235, s38, v235
    s_lshr_b32 s40, s34, 1
    s_lshl_b32 s40, s40, 2
    s_mul_i32 s39, s35, 12288
    s_add_u32 s41, s39, 4096
    s_add_u32 s42, s39, 8192
    s_mov_b32 s36, 0
    s_xor_b32 s56, s34, 1
    s_lshl_b32 s56, s56, 8
    s_lshl_b32 s38, s35, 2
    s_add_u32 s56, s56, s38
    v_mov_b32 v234, 0
    s_lshl_b32 s41, s35, 10
    s_add_u32 m0, s41, 143360
    s_add_u32 s38, s101, 147456
    buffer_load_dwordx4 v240, s[24:27], s38 offen lds
    s_add_u32 m0, s41, 147456
    s_add_u32 s38, s52, 184320
    buffer_load_dwordx4 v228, s[24:27], s38 offen lds
    s_add_u32 m0, s41, 151552
    s_add_u32 s38, s52, 184448
    buffer_load_dwordx4 v228, s[24:27], s38 offen lds
    s_add_u32 m0, s41, 155648
    s_add_u32 s38, s52, 184576
    buffer_load_dwordx4 v228, s[24:27], s38 offen lds
    s_add_u32 m0, s41, 159744
    s_add_u32 s38, s52, 184704
    buffer_load_dwordx4 v228, s[24:27], s38 offen lds
    s_waitcnt lgkmcnt(10)
    v_or3_b32 v128, v128, v129, v130
    v_or3_b32 v131, v131, v132, v133
    v_or3_b32 v128, v128, v134, v135
    v_or_b32 v128, v128, v131
    s_lshl_b32 s41, s35, 10
    v_readfirstlane_b32 s40, v128
    s_cmp_eq_u32 s61, 0
    s_cselect_b32 s40, s40, 0
    s_cmp_lg_u32 s40, 0
    s_barrier
    s_cbranch_scc1 L_fallback
    ds_read_b128 v[40:43], v208 offset:0
    ds_read_b128 v[44:47], v208 offset:1024
    ds_read_b128 v[48:51], v209 offset:2048
    ds_read_b128 v[52:55], v209 offset:3072
    ds_read_b128 v[56:59], v209 offset:4096
    s_mul_i32 s39, s35, 12288
    s_add_u32 s41, s39, 4096
    s_lshr_b32 s40, s34, 1
    s_lshl_b32 s40, s40, 2
    s_waitcnt lgkmcnt(0)
    v_mfma_f32_16x16x32_bf16 v[96:99], v[0:3], v[40:43], 0
    ds_read_b128 v[188:191], v208 offset:5120
    v_mfma_f32_16x16x32_bf16 v[100:103], v[0:3], v[44:47], 0
    ds_read_b128 v[192:195], v208 offset:6144
    v_mfma_f32_16x16x32_bf16 v[104:107], v[0:3], v[48:51], 0
    ds_read_b128 v[196:199], v209 offset:7168
    v_mfma_f32_16x16x32_bf16 v[108:111], v[0:3], v[52:55], 0
    ds_read_b128 v[200:203], v209 offset:8192
    v_mfma_f32_16x16x32_bf16 v[112:115], v[0:3], v[56:59], 0
    ds_read_b128 v[204:207], v209 offset:9216
    v_mfma_f32_16x16x32_bf16 v[116:119], v[4:7], v[40:43], 0
    ds_read_b64_tr_b16 v[20:21], v236 offset:20480
    v_mfma_f32_16x16x32_bf16 v[120:123], v[4:7], v[44:47], 0
    ds_read_b64_tr_b16 v[22:23], v236 offset:22528
    v_mfma_f32_16x16x32_bf16 v[124:127], v[4:7], v[48:51], 0
    ds_read_b64_tr_b16 v[24:25], v236 offset:24576
    v_mfma_f32_16x16x32_bf16 v[128:131], v[4:7], v[52:55], 0
    ds_read_b64_tr_b16 v[26:27], v236 offset:26624
    v_mfma_f32_16x16x32_bf16 v[132:135], v[4:7], v[56:59], 0
    ds_read_b64_tr_b16 v[28:29], v236 offset:28672
    v_mfma_f32_16x16x32_bf16 v[148:151], v[8:11], v[40:43], 0
    ds_read_b64_tr_b16 v[30:31], v236 offset:30720
    v_mfma_f32_16x16x32_bf16 v[152:155], v[8:11], v[44:47], 0
    ds_read_b64_tr_b16 v[32:33], v236 offset:32768
    v_mfma_f32_16x16x32_bf16 v[156:159], v[8:11], v[48:51], 0
    ds_read_b64_tr_b16 v[34:35], v236 offset:34816
    v_mfma_f32_16x16x32_bf16 v[160:163], v[8:11], v[52:55], 0
    ds_read_b64_tr_b16 v[36:37], v245 offset:18432
    v_mfma_f32_16x16x32_bf16 v[164:167], v[8:11], v[56:59], 0
    ds_read_b64_tr_b16 v[38:39], v245 offset:19456
    v_mfma_f32_16x16x32_bf16 v[168:171], v[12:15], v[40:43], 0
    v_mfma_f32_16x16x32_bf16 v[172:175], v[12:15], v[44:47], 0
    v_mfma_f32_16x16x32_bf16 v[176:179], v[12:15], v[48:51], 0
    v_mfma_f32_16x16x32_bf16 v[180:183], v[12:15], v[52:55], 0
    s_waitcnt vmcnt(5)
    s_mov_b64 exec, 1
    buffer_store_dword v231, v234, s[4:7], s56 offen offset:128 sc1
    s_mov_b64 exec, -1
    v_mfma_f32_16x16x32_bf16 v[184:187], v[12:15], v[56:59], 0
    v_mfma_f32_16x16x32_bf16 v[136:139], v[16:19], v[40:43], 0
    v_mfma_f32_16x16x32_bf16 v[140:143], v[16:19], v[44:47], 0
    v_mfma_f32_16x16x32_bf16 v[144:147], v[16:19], v[48:51], 0
    s_waitcnt lgkmcnt(0)
    v_mfma_f32_16x16x32_bf16 v[96:99], v[20:23], v[188:191], v[96:99]
    ds_read_b128 v[40:43], v208 offset:10240
    v_mfma_f32_16x16x32_bf16 v[100:103], v[20:23], v[192:195], v[100:103]
    ds_read_b128 v[44:47], v208 offset:11264
    v_mfma_f32_16x16x32_bf16 v[104:107], v[20:23], v[196:199], v[104:107]
    ds_read_b128 v[48:51], v209 offset:12288
    v_mfma_f32_16x16x32_bf16 v[108:111], v[20:23], v[200:203], v[108:111]
    ds_read_b128 v[52:55], v209 offset:13312
    v_mfma_f32_16x16x32_bf16 v[112:115], v[20:23], v[204:207], v[112:115]
    ds_read_b128 v[56:59], v209 offset:14336
    v_mfma_f32_16x16x32_bf16 v[116:119], v[24:27], v[188:191], v[116:119]
    s_barrier
    ds_read_b64_tr_b16 v[0:1], v237 offset:0
    v_mfma_f32_16x16x32_bf16 v[120:123], v[24:27], v[192:195], v[120:123]
    ds_read_b64_tr_b16 v[2:3], v237 offset:2048
    v_mfma_f32_16x16x32_bf16 v[124:127], v[24:27], v[196:199], v[124:127]
    ds_read_b64_tr_b16 v[4:5], v237 offset:4096
    v_mfma_f32_16x16x32_bf16 v[128:131], v[24:27], v[200:203], v[128:131]
    ds_read_b64_tr_b16 v[6:7], v237 offset:6144
    v_mfma_f32_16x16x32_bf16 v[132:135], v[24:27], v[204:207], v[132:135]
    ds_read_b64_tr_b16 v[8:9], v237 offset:8192
    v_mfma_f32_16x16x32_bf16 v[148:151], v[28:31], v[188:191], v[148:151]
    ds_read_b64_tr_b16 v[10:11], v237 offset:10240
    v_mfma_f32_16x16x32_bf16 v[152:155], v[28:31], v[192:195], v[152:155]
    ds_read_b64_tr_b16 v[12:13], v237 offset:12288
    v_mfma_f32_16x16x32_bf16 v[156:159], v[28:31], v[196:199], v[156:159]
    ds_read_b64_tr_b16 v[14:15], v237 offset:14336
    v_mfma_f32_16x16x32_bf16 v[160:163], v[28:31], v[200:203], v[160:163]
    ds_read_b64_tr_b16 v[16:17], v246 offset:16384
    v_mfma_f32_16x16x32_bf16 v[164:167], v[28:31], v[204:207], v[164:167]
    ds_read_b64_tr_b16 v[18:19], v246 offset:17408
    v_mfma_f32_16x16x32_bf16 v[168:171], v[32:35], v[188:191], v[168:171]
    v_mfma_f32_16x16x32_bf16 v[172:175], v[32:35], v[192:195], v[172:175]
    v_mfma_f32_16x16x32_bf16 v[176:179], v[32:35], v[196:199], v[176:179]
    v_mfma_f32_16x16x32_bf16 v[180:183], v[32:35], v[200:203], v[180:183]
    v_mfma_f32_16x16x32_bf16 v[184:187], v[32:35], v[204:207], v[184:187]
    v_mfma_f32_16x16x32_bf16 v[136:139], v[36:39], v[188:191], v[136:139]
    v_mfma_f32_16x16x32_bf16 v[140:143], v[36:39], v[192:195], v[140:143]
    v_mfma_f32_16x16x32_bf16 v[144:147], v[36:39], v[196:199], v[144:147]
    s_waitcnt lgkmcnt(0)
    v_mfma_f32_16x16x32_bf16 v[96:99], v[0:3], v[40:43], v[96:99]
    ds_read_b128 v[188:191], v208 offset:15360
    v_mfma_f32_16x16x32_bf16 v[100:103], v[0:3], v[44:47], v[100:103]
    ds_read_b128 v[192:195], v208 offset:16384
    v_mfma_f32_16x16x32_bf16 v[104:107], v[0:3], v[48:51], v[104:107]
    ds_read_b128 v[196:199], v209 offset:17408
    v_mfma_f32_16x16x32_bf16 v[108:111], v[0:3], v[52:55], v[108:111]
    ds_read_b128 v[200:203], v209 offset:18432
    v_mfma_f32_16x16x32_bf16 v[112:115], v[0:3], v[56:59], v[112:115]
    ds_read_b128 v[204:207], v209 offset:19456
    v_mfma_f32_16x16x32_bf16 v[116:119], v[4:7], v[40:43], v[116:119]
    ds_read_b64_tr_b16 v[20:21], v237 offset:20480
    v_mfma_f32_16x16x32_bf16 v[120:123], v[4:7], v[44:47], v[120:123]
    ds_read_b64_tr_b16 v[22:23], v237 offset:22528
    v_mfma_f32_16x16x32_bf16 v[124:127], v[4:7], v[48:51], v[124:127]
    ds_read_b64_tr_b16 v[24:25], v237 offset:24576
    v_mfma_f32_16x16x32_bf16 v[128:131], v[4:7], v[52:55], v[128:131]
    ds_read_b64_tr_b16 v[26:27], v237 offset:26624
    v_mfma_f32_16x16x32_bf16 v[132:135], v[4:7], v[56:59], v[132:135]
    ds_read_b64_tr_b16 v[28:29], v237 offset:28672
    v_mfma_f32_16x16x32_bf16 v[148:151], v[8:11], v[40:43], v[148:151]
    ds_read_b64_tr_b16 v[30:31], v237 offset:30720
    v_mfma_f32_16x16x32_bf16 v[152:155], v[8:11], v[44:47], v[152:155]
    ds_read_b64_tr_b16 v[32:33], v237 offset:32768
    v_mfma_f32_16x16x32_bf16 v[156:159], v[8:11], v[48:51], v[156:159]
    ds_read_b64_tr_b16 v[34:35], v237 offset:34816
    v_mfma_f32_16x16x32_bf16 v[160:163], v[8:11], v[52:55], v[160:163]
    ds_read_b64_tr_b16 v[36:37], v246 offset:18432
    v_mfma_f32_16x16x32_bf16 v[164:167], v[8:11], v[56:59], v[164:167]
    ds_read_b64_tr_b16 v[38:39], v246 offset:19456
    v_mfma_f32_16x16x32_bf16 v[168:171], v[12:15], v[40:43], v[168:171]
    v_mfma_f32_16x16x32_bf16 v[172:175], v[12:15], v[44:47], v[172:175]
    v_mfma_f32_16x16x32_bf16 v[176:179], v[12:15], v[48:51], v[176:179]
    v_mfma_f32_16x16x32_bf16 v[180:183], v[12:15], v[52:55], v[180:183]
    v_mfma_f32_16x16x32_bf16 v[184:187], v[12:15], v[56:59], v[184:187]
    v_mfma_f32_16x16x32_bf16 v[136:139], v[16:19], v[40:43], v[136:139]
    v_mfma_f32_16x16x32_bf16 v[140:143], v[16:19], v[44:47], v[140:143]
    v_mfma_f32_16x16x32_bf16 v[144:147], v[16:19], v[48:51], v[144:147]
    s_waitcnt lgkmcnt(0)
    v_mfma_f32_16x16x32_bf16 v[96:99], v[20:23], v[188:191], v[96:99]
    ds_read_b128 v[40:43], v208 offset:20480
    v_mfma_f32_16x16x32_bf16 v[100:103], v[20:23], v[192:195], v[100:103]
    ds_read_b128 v[44:47], v208 offset:21504
    v_mfma_f32_16x16x32_bf16 v[104:107], v[20:23], v[196:199], v[104:107]
    ds_read_b128 v[48:51], v209 offset:22528
    v_mfma_f32_16x16x32_bf16 v[108:111], v[20:23], v[200:203], v[108:111]
    ds_read_b128 v[52:55], v209 offset:23552
    v_mfma_f32_16x16x32_bf16 v[112:115], v[20:23], v[204:207], v[112:115]
    ds_read_b128 v[56:59], v209 offset:24576
    v_mfma_f32_16x16x32_bf16 v[116:119], v[24:27], v[188:191], v[116:119]
    s_waitcnt vmcnt(1)
    s_barrier
    ds_read_b64_tr_b16 v[0:1], v238 offset:0
    v_mfma_f32_16x16x32_bf16 v[120:123], v[24:27], v[192:195], v[120:123]
    ds_read_b64_tr_b16 v[2:3], v238 offset:2048
    v_mfma_f32_16x16x32_bf16 v[124:127], v[24:27], v[196:199], v[124:127]
    ds_read_b64_tr_b16 v[4:5], v238 offset:4096
    v_mfma_f32_16x16x32_bf16 v[128:131], v[24:27], v[200:203], v[128:131]
    ds_read_b64_tr_b16 v[6:7], v238 offset:6144
    v_mfma_f32_16x16x32_bf16 v[132:135], v[24:27], v[204:207], v[132:135]
    ds_read_b64_tr_b16 v[8:9], v238 offset:8192
    v_mfma_f32_16x16x32_bf16 v[148:151], v[28:31], v[188:191], v[148:151]
    ds_read_b64_tr_b16 v[10:11], v238 offset:10240
    v_mfma_f32_16x16x32_bf16 v[152:155], v[28:31], v[192:195], v[152:155]
    ds_read_b64_tr_b16 v[12:13], v238 offset:12288
    v_mfma_f32_16x16x32_bf16 v[156:159], v[28:31], v[196:199], v[156:159]
    ds_read_b64_tr_b16 v[14:15], v238 offset:14336
    v_mfma_f32_16x16x32_bf16 v[160:163], v[28:31], v[200:203], v[160:163]
    ds_read_b64_tr_b16 v[16:17], v247 offset:16384
    v_mfma_f32_16x16x32_bf16 v[164:167], v[28:31], v[204:207], v[164:167]
    ds_read_b64_tr_b16 v[18:19], v247 offset:17408
    v_mfma_f32_16x16x32_bf16 v[168:171], v[32:35], v[188:191], v[168:171]
    v_mfma_f32_16x16x32_bf16 v[172:175], v[32:35], v[192:195], v[172:175]
    v_mfma_f32_16x16x32_bf16 v[176:179], v[32:35], v[196:199], v[176:179]
    v_mfma_f32_16x16x32_bf16 v[180:183], v[32:35], v[200:203], v[180:183]
    v_mfma_f32_16x16x32_bf16 v[184:187], v[32:35], v[204:207], v[184:187]
    v_mfma_f32_16x16x32_bf16 v[136:139], v[36:39], v[188:191], v[136:139]
    v_mfma_f32_16x16x32_bf16 v[140:143], v[36:39], v[192:195], v[140:143]
    v_mfma_f32_16x16x32_bf16 v[144:147], v[36:39], v[196:199], v[144:147]
    s_waitcnt lgkmcnt(0)
    v_mfma_f32_16x16x32_bf16 v[96:99], v[0:3], v[40:43], v[96:99]
    ds_read_b128 v[188:191], v208 offset:25600
    v_mfma_f32_16x16x32_bf16 v[100:103], v[0:3], v[44:47], v[100:103]
    ds_read_b128 v[192:195], v208 offset:26624
    v_mfma_f32_16x16x32_bf16 v[104:107], v[0:3], v[48:51], v[104:107]
    ds_read_b128 v[196:199], v209 offset:27648
    v_mfma_f32_16x16x32_bf16 v[108:111], v[0:3], v[52:55], v[108:111]
    ds_read_b128 v[200:203], v209 offset:28672
    v_mfma_f32_16x16x32_bf16 v[112:115], v[0:3], v[56:59], v[112:115]
    ds_read_b128 v[204:207], v209 offset:29696
    v_mfma_f32_16x16x32_bf16 v[116:119], v[4:7], v[40:43], v[116:119]
    ds_read_b64_tr_b16 v[20:21], v238 offset:20480
    v_mfma_f32_16x16x32_bf16 v[120:123], v[4:7], v[44:47], v[120:123]
    ds_read_b64_tr_b16 v[22:23], v238 offset:22528
    v_mfma_f32_16x16x32_bf16 v[124:127], v[4:7], v[48:51], v[124:127]
    ds_read_b64_tr_b16 v[24:25], v238 offset:24576
    v_mfma_f32_16x16x32_bf16 v[128:131], v[4:7], v[52:55], v[128:131]
    ds_read_b64_tr_b16 v[26:27], v238 offset:26624
    v_mfma_f32_16x16x32_bf16 v[132:135], v[4:7], v[56:59], v[132:135]
    ds_read_b64_tr_b16 v[28:29], v238 offset:28672
    v_mfma_f32_16x16x32_bf16 v[148:151], v[8:11], v[40:43], v[148:151]
    ds_read_b64_tr_b16 v[30:31], v238 offset:30720
    v_mfma_f32_16x16x32_bf16 v[152:155], v[8:11], v[44:47], v[152:155]
    ds_read_b64_tr_b16 v[32:33], v238 offset:32768
    v_mfma_f32_16x16x32_bf16 v[156:159], v[8:11], v[48:51], v[156:159]
    ds_read_b64_tr_b16 v[34:35], v238 offset:34816
    v_mfma_f32_16x16x32_bf16 v[160:163], v[8:11], v[52:55], v[160:163]
    ds_read_b64_tr_b16 v[36:37], v247 offset:18432
    v_mfma_f32_16x16x32_bf16 v[164:167], v[8:11], v[56:59], v[164:167]
    ds_read_b64_tr_b16 v[38:39], v247 offset:19456
    v_mfma_f32_16x16x32_bf16 v[168:171], v[12:15], v[40:43], v[168:171]
    v_mfma_f32_16x16x32_bf16 v[172:175], v[12:15], v[44:47], v[172:175]
    v_mfma_f32_16x16x32_bf16 v[176:179], v[12:15], v[48:51], v[176:179]
    v_mfma_f32_16x16x32_bf16 v[180:183], v[12:15], v[52:55], v[180:183]
    v_mfma_f32_16x16x32_bf16 v[184:187], v[12:15], v[56:59], v[184:187]
    v_mfma_f32_16x16x32_bf16 v[136:139], v[16:19], v[40:43], v[136:139]
    v_mfma_f32_16x16x32_bf16 v[140:143], v[16:19], v[44:47], v[140:143]
    v_mfma_f32_16x16x32_bf16 v[144:147], v[16:19], v[48:51], v[144:147]
    s_waitcnt lgkmcnt(0)
    v_mfma_f32_16x16x32_bf16 v[96:99], v[20:23], v[188:191], v[96:99]
    ds_read_b128 v[40:43], v208 offset:30720
    v_mfma_f32_16x16x32_bf16 v[100:103], v[20:23], v[192:195], v[100:103]
    ds_read_b128 v[44:47], v208 offset:31744
    v_mfma_f32_16x16x32_bf16 v[104:107], v[20:23], v[196:199], v[104:107]
    ds_read_b128 v[48:51], v209 offset:32768
    v_mfma_f32_16x16x32_bf16 v[108:111], v[20:23], v[200:203], v[108:111]
    ds_read_b128 v[52:55], v209 offset:33792
    v_mfma_f32_16x16x32_bf16 v[112:115], v[20:23], v[204:207], v[112:115]
    ds_read_b128 v[56:59], v209 offset:34816
    v_mfma_f32_16x16x32_bf16 v[116:119], v[24:27], v[188:191], v[116:119]
    s_barrier
    ds_read_b64_tr_b16 v[0:1], v236 offset:0
    v_mfma_f32_16x16x32_bf16 v[120:123], v[24:27], v[192:195], v[120:123]
    ds_read_b64_tr_b16 v[2:3], v236 offset:2048
    v_mfma_f32_16x16x32_bf16 v[124:127], v[24:27], v[196:199], v[124:127]
    ds_read_b64_tr_b16 v[4:5], v236 offset:4096
    v_mfma_f32_16x16x32_bf16 v[128:131], v[24:27], v[200:203], v[128:131]
    ds_read_b64_tr_b16 v[6:7], v236 offset:6144
    v_mfma_f32_16x16x32_bf16 v[132:135], v[24:27], v[204:207], v[132:135]
    ds_read_b64_tr_b16 v[8:9], v236 offset:8192
    v_mfma_f32_16x16x32_bf16 v[148:151], v[28:31], v[188:191], v[148:151]
    ds_read_b64_tr_b16 v[10:11], v236 offset:10240
    v_mfma_f32_16x16x32_bf16 v[152:155], v[28:31], v[192:195], v[152:155]
    ds_read_b64_tr_b16 v[12:13], v236 offset:12288
    v_mfma_f32_16x16x32_bf16 v[156:159], v[28:31], v[196:199], v[156:159]
    ds_read_b64_tr_b16 v[14:15], v236 offset:14336
    v_mfma_f32_16x16x32_bf16 v[160:163], v[28:31], v[200:203], v[160:163]
    ds_read_b64_tr_b16 v[16:17], v245 offset:16384
    v_mfma_f32_16x16x32_bf16 v[164:167], v[28:31], v[204:207], v[164:167]
    ds_read_b64_tr_b16 v[18:19], v245 offset:17408
    v_mfma_f32_16x16x32_bf16 v[168:171], v[32:35], v[188:191], v[168:171]
    v_mfma_f32_16x16x32_bf16 v[172:175], v[32:35], v[192:195], v[172:175]
    v_mfma_f32_16x16x32_bf16 v[176:179], v[32:35], v[196:199], v[176:179]
    v_mfma_f32_16x16x32_bf16 v[180:183], v[32:35], v[200:203], v[180:183]
    v_mfma_f32_16x16x32_bf16 v[184:187], v[32:35], v[204:207], v[184:187]
    v_mfma_f32_16x16x32_bf16 v[136:139], v[36:39], v[188:191], v[136:139]
    v_mfma_f32_16x16x32_bf16 v[140:143], v[36:39], v[192:195], v[140:143]
    v_mfma_f32_16x16x32_bf16 v[144:147], v[36:39], v[196:199], v[144:147]
    s_waitcnt lgkmcnt(0)
    v_mfma_f32_16x16x32_bf16 v[96:99], v[0:3], v[40:43], v[96:99]
    ds_read_b128 v[188:191], v208 offset:35840
    v_mfma_f32_16x16x32_bf16 v[100:103], v[0:3], v[44:47], v[100:103]
    ds_read_b128 v[192:195], v208 offset:36864
    v_mfma_f32_16x16x32_bf16 v[104:107], v[0:3], v[48:51], v[104:107]
    ds_read_b128 v[196:199], v209 offset:37888
    v_mfma_f32_16x16x32_bf16 v[108:111], v[0:3], v[52:55], v[108:111]
    ds_read_b128 v[200:203], v209 offset:38912
    v_mfma_f32_16x16x32_bf16 v[112:115], v[0:3], v[56:59], v[112:115]
    ds_read_b128 v[204:207], v209 offset:39936
    v_mfma_f32_16x16x32_bf16 v[116:119], v[4:7], v[40:43], v[116:119]
    ds_read_b64_tr_b16 v[20:21], v236 offset:20480
    v_mfma_f32_16x16x32_bf16 v[120:123], v[4:7], v[44:47], v[120:123]
    ds_read_b64_tr_b16 v[22:23], v236 offset:22528
    v_mfma_f32_16x16x32_bf16 v[124:127], v[4:7], v[48:51], v[124:127]
    ds_read_b64_tr_b16 v[24:25], v236 offset:24576
    v_mfma_f32_16x16x32_bf16 v[128:131], v[4:7], v[52:55], v[128:131]
    ds_read_b64_tr_b16 v[26:27], v236 offset:26624
    v_mfma_f32_16x16x32_bf16 v[132:135], v[4:7], v[56:59], v[132:135]
    ds_read_b64_tr_b16 v[28:29], v236 offset:28672
    v_mfma_f32_16x16x32_bf16 v[148:151], v[8:11], v[40:43], v[148:151]
    ds_read_b64_tr_b16 v[30:31], v236 offset:30720
    v_mfma_f32_16x16x32_bf16 v[152:155], v[8:11], v[44:47], v[152:155]
    ds_read_b64_tr_b16 v[32:33], v236 offset:32768
    v_mfma_f32_16x16x32_bf16 v[156:159], v[8:11], v[48:51], v[156:159]
    ds_read_b64_tr_b16 v[34:35], v236 offset:34816
    v_mfma_f32_16x16x32_bf16 v[160:163], v[8:11], v[52:55], v[160:163]
    ds_read_b64_tr_b16 v[36:37], v245 offset:18432
    v_mfma_f32_16x16x32_bf16 v[164:167], v[8:11], v[56:59], v[164:167]
    ds_read_b64_tr_b16 v[38:39], v245 offset:19456
    v_mfma_f32_16x16x32_bf16 v[168:171], v[12:15], v[40:43], v[168:171]
    v_mfma_f32_16x16x32_bf16 v[172:175], v[12:15], v[44:47], v[172:175]
    v_mfma_f32_16x16x32_bf16 v[176:179], v[12:15], v[48:51], v[176:179]
    v_mfma_f32_16x16x32_bf16 v[180:183], v[12:15], v[52:55], v[180:183]
    v_mfma_f32_16x16x32_bf16 v[184:187], v[12:15], v[56:59], v[184:187]
    v_mfma_f32_16x16x32_bf16 v[136:139], v[16:19], v[40:43], v[136:139]
    v_mfma_f32_16x16x32_bf16 v[140:143], v[16:19], v[44:47], v[140:143]
    v_mfma_f32_16x16x32_bf16 v[144:147], v[16:19], v[48:51], v[144:147]
    s_waitcnt lgkmcnt(0)
    v_mfma_f32_16x16x32_bf16 v[96:99], v[20:23], v[188:191], v[96:99]
    v_mfma_f32_16x16x32_bf16 v[100:103], v[20:23], v[192:195], v[100:103]
    v_mfma_f32_16x16x32_bf16 v[104:107], v[20:23], v[196:199], v[104:107]
    v_mfma_f32_16x16x32_bf16 v[108:111], v[20:23], v[200:203], v[108:111]
    v_mfma_f32_16x16x32_bf16 v[112:115], v[20:23], v[204:207], v[112:115]
    s_barrier
    ds_read_b128 v[40:43], v208 offset:0
    v_mfma_f32_16x16x32_bf16 v[116:119], v[24:27], v[188:191], v[116:119]
    ds_read_b128 v[44:47], v208 offset:1024
    v_mfma_f32_16x16x32_bf16 v[120:123], v[24:27], v[192:195], v[120:123]
    ds_read_b128 v[48:51], v209 offset:2048
    v_mfma_f32_16x16x32_bf16 v[124:127], v[24:27], v[196:199], v[124:127]
    ds_read_b128 v[52:55], v209 offset:3072
    v_mfma_f32_16x16x32_bf16 v[128:131], v[24:27], v[200:203], v[128:131]
    ds_read_b128 v[56:59], v209 offset:4096
    v_mfma_f32_16x16x32_bf16 v[132:135], v[24:27], v[204:207], v[132:135]
    ds_read_b64_tr_b16 v[0:1], v237 offset:0
    v_mfma_f32_16x16x32_bf16 v[148:151], v[28:31], v[188:191], v[148:151]
    ds_read_b64_tr_b16 v[2:3], v237 offset:2048
    v_mfma_f32_16x16x32_bf16 v[152:155], v[28:31], v[192:195], v[152:155]
    ds_read_b64_tr_b16 v[4:5], v237 offset:4096
    v_mfma_f32_16x16x32_bf16 v[156:159], v[28:31], v[196:199], v[156:159]
    ds_read_b64_tr_b16 v[6:7], v237 offset:6144
    v_mfma_f32_16x16x32_bf16 v[160:163], v[28:31], v[200:203], v[160:163]
    ds_read_b64_tr_b16 v[16:17], v246 offset:8192
    v_mfma_f32_16x16x32_bf16 v[164:167], v[28:31], v[204:207], v[164:167]
    ds_read_b64_tr_b16 v[18:19], v246 offset:9216
    v_mfma_f32_16x16x32_bf16 v[168:171], v[32:35], v[188:191], v[168:171]
    v_mfma_f32_16x16x32_bf16 v[172:175], v[32:35], v[192:195], v[172:175]
    v_mfma_f32_16x16x32_bf16 v[176:179], v[32:35], v[196:199], v[176:179]
    v_mfma_f32_16x16x32_bf16 v[180:183], v[32:35], v[200:203], v[180:183]
    v_mfma_f32_16x16x32_bf16 v[184:187], v[32:35], v[204:207], v[184:187]
    v_mfma_f32_16x16x32_bf16 v[136:139], v[36:39], v[188:191], v[136:139]
    v_mfma_f32_16x16x32_bf16 v[140:143], v[36:39], v[192:195], v[140:143]
    v_mfma_f32_16x16x32_bf16 v[144:147], v[36:39], v[196:199], v[144:147]
    s_waitcnt lgkmcnt(0)
    v_mfma_f32_16x16x32_bf16 v[96:99], v[0:3], v[40:43], v[96:99]
    ds_read_b128 v[188:191], v208 offset:5120
    v_mfma_f32_16x16x32_bf16 v[100:103], v[0:3], v[44:47], v[100:103]
    ds_read_b128 v[192:195], v208 offset:6144
    v_mfma_f32_16x16x32_bf16 v[104:107], v[0:3], v[48:51], v[104:107]
    ds_read_b128 v[196:199], v209 offset:7168
    v_mfma_f32_16x16x32_bf16 v[108:111], v[0:3], v[52:55], v[108:111]
    ds_read_b128 v[200:203], v209 offset:8192
    v_mfma_f32_16x16x32_bf16 v[112:115], v[0:3], v[56:59], v[112:115]
    ds_read_b128 v[204:207], v209 offset:9216
    v_mfma_f32_16x16x32_bf16 v[116:119], v[4:7], v[40:43], v[116:119]
    ds_read_b64_tr_b16 v[20:21], v237 offset:12288
    v_mfma_f32_16x16x32_bf16 v[120:123], v[4:7], v[44:47], v[120:123]
    ds_read_b64_tr_b16 v[22:23], v237 offset:14336
    v_mfma_f32_16x16x32_bf16 v[124:127], v[4:7], v[48:51], v[124:127]
    ds_read_b64_tr_b16 v[24:25], v237 offset:16384
    v_mfma_f32_16x16x32_bf16 v[128:131], v[4:7], v[52:55], v[128:131]
    ds_read_b64_tr_b16 v[26:27], v237 offset:18432
    v_mfma_f32_16x16x32_bf16 v[132:135], v[4:7], v[56:59], v[132:135]
    ds_read_b64_tr_b16 v[36:37], v246 offset:10240
    v_mfma_f32_16x16x32_bf16 v[136:139], v[16:19], v[40:43], v[136:139]
    ds_read_b64_tr_b16 v[38:39], v246 offset:11264
    v_mfma_f32_16x16x32_bf16 v[140:143], v[16:19], v[44:47], v[140:143]
    v_mfma_f32_16x16x32_bf16 v[144:147], v[16:19], v[48:51], v[144:147]
    s_waitcnt lgkmcnt(4)
    v_mfma_f32_16x16x32_bf16 v[96:99], v[20:23], v[188:191], v[96:99]
    ds_read_b128 v[40:43], v208 offset:10240
    v_mfma_f32_16x16x32_bf16 v[100:103], v[20:23], v[192:195], v[100:103]
    ds_read_b128 v[44:47], v208 offset:11264
    v_mfma_f32_16x16x32_bf16 v[104:107], v[20:23], v[196:199], v[104:107]
    ds_read_b128 v[48:51], v209 offset:12288
    v_mfma_f32_16x16x32_bf16 v[108:111], v[20:23], v[200:203], v[108:111]
    ds_read_b128 v[52:55], v209 offset:13312
    v_mfma_f32_16x16x32_bf16 v[112:115], v[20:23], v[204:207], v[112:115]
    ds_read_b128 v[56:59], v209 offset:14336
    s_waitcnt lgkmcnt(5)
    v_mfma_f32_16x16x32_bf16 v[116:119], v[24:27], v[188:191], v[116:119]
    ds_read_b64_tr_b16 v[0:1], v237 offset:20480
    v_mfma_f32_16x16x32_bf16 v[120:123], v[24:27], v[192:195], v[120:123]
    ds_read_b64_tr_b16 v[2:3], v237 offset:22528
    v_mfma_f32_16x16x32_bf16 v[124:127], v[24:27], v[196:199], v[124:127]
    ds_read_b64_tr_b16 v[4:5], v237 offset:24576
    v_mfma_f32_16x16x32_bf16 v[128:131], v[24:27], v[200:203], v[128:131]
    ds_read_b64_tr_b16 v[6:7], v237 offset:26624
    v_mfma_f32_16x16x32_bf16 v[132:135], v[24:27], v[204:207], v[132:135]
    ds_read_b64_tr_b16 v[16:17], v246 offset:28672
    v_mfma_f32_16x16x32_bf16 v[136:139], v[36:39], v[188:191], v[136:139]
    ds_read_b64_tr_b16 v[18:19], v246 offset:29696
    v_mfma_f32_16x16x32_bf16 v[140:143], v[36:39], v[192:195], v[140:143]
    v_mfma_f32_16x16x32_bf16 v[144:147], v[36:39], v[196:199], v[144:147]
    s_waitcnt lgkmcnt(4)
    v_mfma_f32_16x16x32_bf16 v[96:99], v[0:3], v[40:43], v[96:99]
    ds_read_b64_tr_b16 v[20:21], v237 offset:32768
    v_mfma_f32_16x16x32_bf16 v[100:103], v[0:3], v[44:47], v[100:103]
    ds_read_b64_tr_b16 v[22:23], v237 offset:34816
    v_mfma_f32_16x16x32_bf16 v[104:107], v[0:3], v[48:51], v[104:107]
    ds_read_b64_tr_b16 v[36:37], v246 offset:30720
    v_mfma_f32_16x16x32_bf16 v[108:111], v[0:3], v[52:55], v[108:111]
    ds_read_b64_tr_b16 v[38:39], v246 offset:31744
    v_mfma_f32_16x16x32_bf16 v[112:115], v[0:3], v[56:59], v[112:115]
    ds_read_b128 v[188:191], v208 offset:15360
    s_waitcnt lgkmcnt(5)
    v_mfma_f32_16x16x32_bf16 v[116:119], v[4:7], v[40:43], v[116:119]
    ds_read_b128 v[192:195], v208 offset:16384
    v_mfma_f32_16x16x32_bf16 v[120:123], v[4:7], v[44:47], v[120:123]
    ds_read_b128 v[196:199], v209 offset:17408
    v_mfma_f32_16x16x32_bf16 v[124:127], v[4:7], v[48:51], v[124:127]
    ds_read_b128 v[200:203], v209 offset:18432
    v_mfma_f32_16x16x32_bf16 v[128:131], v[4:7], v[52:55], v[128:131]
    ds_read_b128 v[204:207], v209 offset:19456
    v_mfma_f32_16x16x32_bf16 v[132:135], v[4:7], v[56:59], v[132:135]
    s_waitcnt lgkmcnt(5)
    s_barrier
    ds_read_b64_tr_b16 v[24:25], v238 offset:0
    v_mfma_f32_16x16x32_bf16 v[136:139], v[16:19], v[40:43], v[136:139]
    ds_read_b64_tr_b16 v[26:27], v238 offset:2048
    v_mfma_f32_16x16x32_bf16 v[140:143], v[16:19], v[44:47], v[140:143]
    v_mfma_f32_16x16x32_bf16 v[144:147], v[16:19], v[48:51], v[144:147]
    s_waitcnt lgkmcnt(2)
    v_mfma_f32_16x16x32_bf16 v[96:99], v[20:23], v[188:191], v[96:99]
    ds_read_b128 v[40:43], v208 offset:20480
    v_mfma_f32_16x16x32_bf16 v[100:103], v[20:23], v[192:195], v[100:103]
    ds_read_b128 v[44:47], v208 offset:21504
    v_mfma_f32_16x16x32_bf16 v[104:107], v[20:23], v[196:199], v[104:107]
    ds_read_b128 v[48:51], v209 offset:22528
    v_mfma_f32_16x16x32_bf16 v[108:111], v[20:23], v[200:203], v[108:111]
    ds_read_b128 v[52:55], v209 offset:23552
    v_mfma_f32_16x16x32_bf16 v[112:115], v[20:23], v[204:207], v[112:115]
    ds_read_b128 v[56:59], v209 offset:24576
    s_waitcnt lgkmcnt(5)
    v_mfma_f32_16x16x32_bf16 v[116:119], v[24:27], v[188:191], v[116:119]
    ds_read_b64_tr_b16 v[0:1], v238 offset:4096
    v_mfma_f32_16x16x32_bf16 v[120:123], v[24:27], v[192:195], v[120:123]
    ds_read_b64_tr_b16 v[2:3], v238 offset:6144
    v_mfma_f32_16x16x32_bf16 v[124:127], v[24:27], v[196:199], v[124:127]
    ds_read_b64_tr_b16 v[4:5], v238 offset:8192
    v_mfma_f32_16x16x32_bf16 v[128:131], v[24:27], v[200:203], v[128:131]
    ds_read_b64_tr_b16 v[6:7], v238 offset:10240
    v_mfma_f32_16x16x32_bf16 v[132:135], v[24:27], v[204:207], v[132:135]
    ds_read_b64_tr_b16 v[16:17], v247 offset:12288
    v_mfma_f32_16x16x32_bf16 v[136:139], v[36:39], v[188:191], v[136:139]
    ds_read_b64_tr_b16 v[18:19], v247 offset:13312
    v_mfma_f32_16x16x32_bf16 v[140:143], v[36:39], v[192:195], v[140:143]
    v_mfma_f32_16x16x32_bf16 v[144:147], v[36:39], v[196:199], v[144:147]
    s_waitcnt lgkmcnt(4)
    v_mfma_f32_16x16x32_bf16 v[96:99], v[0:3], v[40:43], v[96:99]
    ds_read_b128 v[188:191], v208 offset:25600
    v_mfma_f32_16x16x32_bf16 v[100:103], v[0:3], v[44:47], v[100:103]
    ds_read_b128 v[192:195], v208 offset:26624
    v_mfma_f32_16x16x32_bf16 v[104:107], v[0:3], v[48:51], v[104:107]
    ds_read_b128 v[196:199], v209 offset:27648
    v_mfma_f32_16x16x32_bf16 v[108:111], v[0:3], v[52:55], v[108:111]
    ds_read_b128 v[200:203], v209 offset:28672
    v_mfma_f32_16x16x32_bf16 v[112:115], v[0:3], v[56:59], v[112:115]
    ds_read_b128 v[204:207], v209 offset:29696
    s_waitcnt lgkmcnt(5)
    v_mfma_f32_16x16x32_bf16 v[116:119], v[4:7], v[40:43], v[116:119]
    ds_read_b64_tr_b16 v[20:21], v238 offset:16384
    v_mfma_f32_16x16x32_bf16 v[120:123], v[4:7], v[44:47], v[120:123]
    ds_read_b64_tr_b16 v[22:23], v238 offset:18432
    v_mfma_f32_16x16x32_bf16 v[124:127], v[4:7], v[48:51], v[124:127]
    ds_read_b64_tr_b16 v[24:25], v238 offset:20480
    v_mfma_f32_16x16x32_bf16 v[128:131], v[4:7], v[52:55], v[128:131]
    ds_read_b64_tr_b16 v[26:27], v238 offset:22528
    v_mfma_f32_16x16x32_bf16 v[132:135], v[4:7], v[56:59], v[132:135]
    ds_read_b64_tr_b16 v[36:37], v247 offset:14336
    v_mfma_f32_16x16x32_bf16 v[136:139], v[16:19], v[40:43], v[136:139]
    ds_read_b64_tr_b16 v[38:39], v247 offset:15360
    v_mfma_f32_16x16x32_bf16 v[140:143], v[16:19], v[44:47], v[140:143]
    v_mfma_f32_16x16x32_bf16 v[144:147], v[16:19], v[48:51], v[144:147]
    s_waitcnt lgkmcnt(4)
    v_mfma_f32_16x16x32_bf16 v[96:99], v[20:23], v[188:191], v[96:99]
    ds_read_b128 v[40:43], v210 offset:30720
    v_mfma_f32_16x16x32_bf16 v[100:103], v[20:23], v[192:195], v[100:103]
    ds_read_b128 v[44:47], v210 offset:31744
    v_mfma_f32_16x16x32_bf16 v[104:107], v[20:23], v[196:199], v[104:107]
    ds_read_b128 v[48:51], v211 offset:32768
    v_mfma_f32_16x16x32_bf16 v[108:111], v[20:23], v[200:203], v[108:111]
    ds_read_b128 v[52:55], v211 offset:33792
    v_mfma_f32_16x16x32_bf16 v[112:115], v[20:23], v[204:207], v[112:115]
    ds_read_b128 v[56:59], v211 offset:34816
    s_waitcnt lgkmcnt(5)
    v_mfma_f32_16x16x32_bf16 v[116:119], v[24:27], v[188:191], v[116:119]
    ds_read_b64_tr_b16 v[0:1], v238 offset:24576
    v_mfma_f32_16x16x32_bf16 v[120:123], v[24:27], v[192:195], v[120:123]
    ds_read_b64_tr_b16 v[2:3], v238 offset:26624
    v_mfma_f32_16x16x32_bf16 v[124:127], v[24:27], v[196:199], v[124:127]
    ds_read_b64_tr_b16 v[4:5], v238 offset:28672
    v_mfma_f32_16x16x32_bf16 v[128:131], v[24:27], v[200:203], v[128:131]
    ds_read_b64_tr_b16 v[6:7], v238 offset:30720
    v_mfma_f32_16x16x32_bf16 v[132:135], v[24:27], v[204:207], v[132:135]
    ds_read_b64_tr_b16 v[16:17], v247 offset:32768
    v_mfma_f32_16x16x32_bf16 v[136:139], v[36:39], v[188:191], v[136:139]
    ds_read_b64_tr_b16 v[18:19], v247 offset:33792
    v_mfma_f32_16x16x32_bf16 v[140:143], v[36:39], v[192:195], v[140:143]
    v_mfma_f32_16x16x32_bf16 v[144:147], v[36:39], v[196:199], v[144:147]
    s_waitcnt lgkmcnt(4)
    v_mfma_f32_16x16x32_bf16 v[96:99], v[0:3], v[40:43], v[96:99]
    ds_read_b64_tr_b16 v[36:37], v247 offset:34816
    v_mfma_f32_16x16x32_bf16 v[100:103], v[0:3], v[44:47], v[100:103]
    ds_read_b64_tr_b16 v[38:39], v247 offset:35840
    v_mfma_f32_16x16x32_bf16 v[104:107], v[0:3], v[48:51], v[104:107]
    ds_read_b128 v[188:191], v210 offset:35840
    v_mfma_f32_16x16x32_bf16 v[108:111], v[0:3], v[52:55], v[108:111]
    ds_read_b128 v[192:195], v210 offset:36864
    v_mfma_f32_16x16x32_bf16 v[112:115], v[0:3], v[56:59], v[112:115]
    ds_read_b128 v[196:199], v211 offset:37888
    s_waitcnt lgkmcnt(5)
    v_mfma_f32_16x16x32_bf16 v[116:119], v[4:7], v[40:43], v[116:119]
    ds_read_b128 v[200:203], v211 offset:38912
    v_mfma_f32_16x16x32_bf16 v[120:123], v[4:7], v[44:47], v[120:123]
    ds_read_b128 v[204:207], v211 offset:39936
    v_mfma_f32_16x16x32_bf16 v[124:127], v[4:7], v[48:51], v[124:127]
    s_waitcnt lgkmcnt(5)
    s_barrier
    ds_read_b64_tr_b16 v[20:21], v236 offset:0
    v_mfma_f32_16x16x32_bf16 v[128:131], v[4:7], v[52:55], v[128:131]
    ds_read_b64_tr_b16 v[22:23], v236 offset:2048
    v_mfma_f32_16x16x32_bf16 v[132:135], v[4:7], v[56:59], v[132:135]
    ds_read_b64_tr_b16 v[24:25], v236 offset:4096
    v_mfma_f32_16x16x32_bf16 v[136:139], v[16:19], v[40:43], v[136:139]
    ds_read_b64_tr_b16 v[26:27], v236 offset:6144
    v_mfma_f32_16x16x32_bf16 v[140:143], v[16:19], v[44:47], v[140:143]
    v_mfma_f32_16x16x32_bf16 v[144:147], v[16:19], v[48:51], v[144:147]
    s_waitcnt lgkmcnt(2)
    v_mfma_f32_16x16x32_bf16 v[96:99], v[20:23], v[188:191], v[96:99]
    ds_read_b128 v[40:43], v208 offset:0
    v_mfma_f32_16x16x32_bf16 v[100:103], v[20:23], v[192:195], v[100:103]
    ds_read_b128 v[44:47], v208 offset:1024
    v_mfma_f32_16x16x32_bf16 v[104:107], v[20:23], v[196:199], v[104:107]
    ds_read_b128 v[48:51], v209 offset:2048
    v_mfma_f32_16x16x32_bf16 v[108:111], v[20:23], v[200:203], v[108:111]
    ds_read_b128 v[52:55], v209 offset:3072
    v_mfma_f32_16x16x32_bf16 v[112:115], v[20:23], v[204:207], v[112:115]
    ds_read_b128 v[56:59], v209 offset:4096
    s_waitcnt lgkmcnt(5)
    v_mfma_f32_16x16x32_bf16 v[116:119], v[24:27], v[188:191], v[116:119]
    ds_read_b64_tr_b16 v[8:9], v236 offset:8192
    v_mfma_f32_16x16x32_bf16 v[120:123], v[24:27], v[192:195], v[120:123]
    ds_read_b64_tr_b16 v[10:11], v236 offset:10240
    v_mfma_f32_16x16x32_bf16 v[124:127], v[24:27], v[196:199], v[124:127]
    ds_read_b64_tr_b16 v[12:13], v236 offset:12288
    v_mfma_f32_16x16x32_bf16 v[128:131], v[24:27], v[200:203], v[128:131]
    ds_read_b64_tr_b16 v[14:15], v236 offset:14336
    v_mfma_f32_16x16x32_bf16 v[132:135], v[24:27], v[204:207], v[132:135]
    v_mfma_f32_16x16x32_bf16 v[136:139], v[36:39], v[188:191], v[136:139]
    v_mfma_f32_16x16x32_bf16 v[140:143], v[36:39], v[192:195], v[140:143]
    v_mfma_f32_16x16x32_bf16 v[144:147], v[36:39], v[196:199], v[144:147]
    s_waitcnt lgkmcnt(2)
    v_mfma_f32_16x16x32_bf16 v[148:151], v[8:11], v[40:43], v[148:151]
    ds_read_b128 v[188:191], v208 offset:5120
    v_mfma_f32_16x16x32_bf16 v[152:155], v[8:11], v[44:47], v[152:155]
    ds_read_b128 v[192:195], v208 offset:6144
    v_mfma_f32_16x16x32_bf16 v[156:159], v[8:11], v[48:51], v[156:159]
    ds_read_b128 v[196:199], v209 offset:7168
    v_mfma_f32_16x16x32_bf16 v[160:163], v[8:11], v[52:55], v[160:163]
    ds_read_b128 v[200:203], v209 offset:8192
    v_mfma_f32_16x16x32_bf16 v[164:167], v[8:11], v[56:59], v[164:167]
    ds_read_b128 v[204:207], v209 offset:9216
    v_cvt_pk_bf16_f32 v64, v96, v97
    s_waitcnt lgkmcnt(5)
    v_mfma_f32_16x16x32_bf16 v[168:171], v[12:15], v[40:43], v[168:171]
    ds_read_b64_tr_b16 v[28:29], v236 offset:16384
    v_cvt_pk_bf16_f32 v65, v98, v99
    v_mfma_f32_16x16x32_bf16 v[172:175], v[12:15], v[44:47], v[172:175]
    ds_read_b64_tr_b16 v[30:31], v236 offset:18432
    v_cvt_pk_bf16_f32 v66, v100, v101
    v_mfma_f32_16x16x32_bf16 v[176:179], v[12:15], v[48:51], v[176:179]
    ds_read_b64_tr_b16 v[32:33], v236 offset:20480
    v_cvt_pk_bf16_f32 v67, v102, v103
    v_mfma_f32_16x16x32_bf16 v[180:183], v[12:15], v[52:55], v[180:183]
    ds_read_b64_tr_b16 v[34:35], v236 offset:22528
    v_mfma_f32_16x16x32_bf16 v[184:187], v[12:15], v[56:59], v[184:187]
    buffer_store_dwordx4 v[64:67], v227, s[28:31], s39 offen offset:0 sc1
    s_waitcnt lgkmcnt(2)
    v_mfma_f32_16x16x32_bf16 v[148:151], v[28:31], v[188:191], v[148:151]
    ds_read_b128 v[40:43], v208 offset:10240
    v_mfma_f32_16x16x32_bf16 v[152:155], v[28:31], v[192:195], v[152:155]
    ds_read_b128 v[44:47], v208 offset:11264
    v_mfma_f32_16x16x32_bf16 v[156:159], v[28:31], v[196:199], v[156:159]
    ds_read_b128 v[48:51], v209 offset:12288
    v_mfma_f32_16x16x32_bf16 v[160:163], v[28:31], v[200:203], v[160:163]
    ds_read_b128 v[52:55], v209 offset:13312
    v_mfma_f32_16x16x32_bf16 v[164:167], v[28:31], v[204:207], v[164:167]
    ds_read_b128 v[56:59], v209 offset:14336
    v_cvt_pk_bf16_f32 v68, v104, v105
    s_waitcnt lgkmcnt(5)
    v_mfma_f32_16x16x32_bf16 v[168:171], v[32:35], v[188:191], v[168:171]
    ds_read_b64_tr_b16 v[8:9], v236 offset:24576
    v_cvt_pk_bf16_f32 v69, v106, v107
    v_mfma_f32_16x16x32_bf16 v[172:175], v[32:35], v[192:195], v[172:175]
    ds_read_b64_tr_b16 v[10:11], v236 offset:26624
    v_cvt_pk_bf16_f32 v70, v108, v109
    v_mfma_f32_16x16x32_bf16 v[176:179], v[32:35], v[196:199], v[176:179]
    ds_read_b64_tr_b16 v[12:13], v236 offset:28672
    v_cvt_pk_bf16_f32 v71, v110, v111
    v_mfma_f32_16x16x32_bf16 v[180:183], v[32:35], v[200:203], v[180:183]
    ds_read_b64_tr_b16 v[14:15], v236 offset:30720
    v_mfma_f32_16x16x32_bf16 v[184:187], v[32:35], v[204:207], v[184:187]
    buffer_store_dwordx4 v[68:71], v227, s[28:31], s39 offen offset:1024 sc1
    s_waitcnt lgkmcnt(2)
    v_mfma_f32_16x16x32_bf16 v[148:151], v[8:11], v[40:43], v[148:151]
    ds_read_b64_tr_b16 v[28:29], v236 offset:32768
    v_mfma_f32_16x16x32_bf16 v[152:155], v[8:11], v[44:47], v[152:155]
    ds_read_b64_tr_b16 v[30:31], v236 offset:34816
    v_mfma_f32_16x16x32_bf16 v[156:159], v[8:11], v[48:51], v[156:159]
    ds_read_b128 v[188:191], v208 offset:15360
    v_mfma_f32_16x16x32_bf16 v[160:163], v[8:11], v[52:55], v[160:163]
    ds_read_b128 v[192:195], v208 offset:16384
    v_mfma_f32_16x16x32_bf16 v[164:167], v[8:11], v[56:59], v[164:167]
    ds_read_b128 v[196:199], v209 offset:17408
    v_cvt_pk_bf16_f32 v72, v112, v113
    s_waitcnt lgkmcnt(5)
    v_mfma_f32_16x16x32_bf16 v[168:171], v[12:15], v[40:43], v[168:171]
    ds_read_b128 v[200:203], v209 offset:18432
    v_cvt_pk_bf16_f32 v73, v114, v115
    v_mfma_f32_16x16x32_bf16 v[172:175], v[12:15], v[44:47], v[172:175]
    ds_read_b128 v[204:207], v209 offset:19456
    v_cvt_pk_bf16_f32 v74, v116, v117
    v_mfma_f32_16x16x32_bf16 v[176:179], v[12:15], v[48:51], v[176:179]
    s_waitcnt lgkmcnt(5)
    s_barrier
    ds_read_b64_tr_b16 v[32:33], v237 offset:0
    v_cvt_pk_bf16_f32 v75, v118, v119
    v_mfma_f32_16x16x32_bf16 v[180:183], v[12:15], v[52:55], v[180:183]
    ds_read_b64_tr_b16 v[34:35], v237 offset:2048
    v_mfma_f32_16x16x32_bf16 v[184:187], v[12:15], v[56:59], v[184:187]
    buffer_store_dwordx4 v[72:75], v227, s[28:31], s39 offen offset:2048 sc1
    s_waitcnt lgkmcnt(2)
    v_mfma_f32_16x16x32_bf16 v[148:151], v[28:31], v[188:191], v[148:151]
    ds_read_b128 v[40:43], v208 offset:20480
    v_mfma_f32_16x16x32_bf16 v[152:155], v[28:31], v[192:195], v[152:155]
    ds_read_b128 v[44:47], v208 offset:21504
    v_mfma_f32_16x16x32_bf16 v[156:159], v[28:31], v[196:199], v[156:159]
    ds_read_b128 v[48:51], v209 offset:22528
    v_mfma_f32_16x16x32_bf16 v[160:163], v[28:31], v[200:203], v[160:163]
    ds_read_b128 v[52:55], v209 offset:23552
    v_mfma_f32_16x16x32_bf16 v[164:167], v[28:31], v[204:207], v[164:167]
    ds_read_b128 v[56:59], v209 offset:24576
    v_cvt_pk_bf16_f32 v76, v120, v121
    s_waitcnt lgkmcnt(5)
    v_mfma_f32_16x16x32_bf16 v[168:171], v[32:35], v[188:191], v[168:171]
    ds_read_b64_tr_b16 v[8:9], v237 offset:4096
    v_cvt_pk_bf16_f32 v77, v122, v123
    v_mfma_f32_16x16x32_bf16 v[172:175], v[32:35], v[192:195], v[172:175]
    ds_read_b64_tr_b16 v[10:11], v237 offset:6144
    v_cvt_pk_bf16_f32 v78, v124, v125
    v_mfma_f32_16x16x32_bf16 v[176:179], v[32:35], v[196:199], v[176:179]
    ds_read_b64_tr_b16 v[12:13], v237 offset:8192
    v_cvt_pk_bf16_f32 v79, v126, v127
    v_mfma_f32_16x16x32_bf16 v[180:183], v[32:35], v[200:203], v[180:183]
    ds_read_b64_tr_b16 v[14:15], v237 offset:10240
    v_mfma_f32_16x16x32_bf16 v[184:187], v[32:35], v[204:207], v[184:187]
    buffer_store_dwordx4 v[76:79], v227, s[28:31], s39 offen offset:3072 sc1
    s_waitcnt lgkmcnt(2)
    v_mfma_f32_16x16x32_bf16 v[148:151], v[8:11], v[40:43], v[148:151]
    ds_read_b128 v[188:191], v208 offset:25600
    v_mfma_f32_16x16x32_bf16 v[152:155], v[8:11], v[44:47], v[152:155]
    ds_read_b128 v[192:195], v208 offset:26624
    v_mfma_f32_16x16x32_bf16 v[156:159], v[8:11], v[48:51], v[156:159]
    ds_read_b128 v[196:199], v209 offset:27648
    v_mfma_f32_16x16x32_bf16 v[160:163], v[8:11], v[52:55], v[160:163]
    ds_read_b128 v[200:203], v209 offset:28672
    v_mfma_f32_16x16x32_bf16 v[164:167], v[8:11], v[56:59], v[164:167]
    ds_read_b128 v[204:207], v209 offset:29696
    v_cvt_pk_bf16_f32 v80, v128, v129
    s_waitcnt lgkmcnt(5)
    v_mfma_f32_16x16x32_bf16 v[168:171], v[12:15], v[40:43], v[168:171]
    ds_read_b64_tr_b16 v[28:29], v237 offset:12288
    v_cvt_pk_bf16_f32 v81, v130, v131
    v_mfma_f32_16x16x32_bf16 v[172:175], v[12:15], v[44:47], v[172:175]
    ds_read_b64_tr_b16 v[30:31], v237 offset:14336
    v_cvt_pk_bf16_f32 v82, v132, v133
    v_mfma_f32_16x16x32_bf16 v[176:179], v[12:15], v[48:51], v[176:179]
    ds_read_b64_tr_b16 v[32:33], v237 offset:16384
    v_cvt_pk_bf16_f32 v83, v134, v135
    v_mfma_f32_16x16x32_bf16 v[180:183], v[12:15], v[52:55], v[180:183]
    ds_read_b64_tr_b16 v[34:35], v237 offset:18432
    v_mfma_f32_16x16x32_bf16 v[184:187], v[12:15], v[56:59], v[184:187]
    buffer_store_dwordx4 v[80:83], v227, s[28:31], s41 offen offset:0 sc1
    s_waitcnt lgkmcnt(2)
    v_mfma_f32_16x16x32_bf16 v[148:151], v[28:31], v[188:191], v[148:151]
    ds_read_b128 v[40:43], v210 offset:30720
    v_mfma_f32_16x16x32_bf16 v[152:155], v[28:31], v[192:195], v[152:155]
    ds_read_b128 v[44:47], v210 offset:31744
    v_mfma_f32_16x16x32_bf16 v[156:159], v[28:31], v[196:199], v[156:159]
    ds_read_b128 v[48:51], v211 offset:32768
    v_mfma_f32_16x16x32_bf16 v[160:163], v[28:31], v[200:203], v[160:163]
    ds_read_b128 v[52:55], v211 offset:33792
    v_mfma_f32_16x16x32_bf16 v[164:167], v[28:31], v[204:207], v[164:167]
    ds_read_b128 v[56:59], v211 offset:34816
    v_cvt_pk_bf16_f32 v84, v136, v137
    s_waitcnt lgkmcnt(5)
    v_mfma_f32_16x16x32_bf16 v[168:171], v[32:35], v[188:191], v[168:171]
    ds_read_b64_tr_b16 v[8:9], v237 offset:20480
    v_cvt_pk_bf16_f32 v85, v138, v139
    v_mfma_f32_16x16x32_bf16 v[172:175], v[32:35], v[192:195], v[172:175]
    ds_read_b64_tr_b16 v[10:11], v237 offset:22528
    v_cvt_pk_bf16_f32 v86, v140, v141
    v_mfma_f32_16x16x32_bf16 v[176:179], v[32:35], v[196:199], v[176:179]
    ds_read_b64_tr_b16 v[12:13], v237 offset:24576
    v_cvt_pk_bf16_f32 v87, v142, v143
    v_mfma_f32_16x16x32_bf16 v[180:183], v[32:35], v[200:203], v[180:183]
    ds_read_b64_tr_b16 v[14:15], v237 offset:26624
    v_mfma_f32_16x16x32_bf16 v[184:187], v[32:35], v[204:207], v[184:187]
    buffer_store_dwordx4 v[84:87], v227, s[28:31], s41 offen offset:1024 sc1
    s_waitcnt lgkmcnt(2)
    v_mfma_f32_16x16x32_bf16 v[148:151], v[8:11], v[40:43], v[148:151]
    ds_read_b128 v[188:191], v210 offset:35840
    v_mfma_f32_16x16x32_bf16 v[152:155], v[8:11], v[44:47], v[152:155]
    ds_read_b128 v[192:195], v210 offset:36864
    v_mfma_f32_16x16x32_bf16 v[156:159], v[8:11], v[48:51], v[156:159]
    ds_read_b128 v[196:199], v211 offset:37888
    v_mfma_f32_16x16x32_bf16 v[160:163], v[8:11], v[52:55], v[160:163]
    ds_read_b128 v[200:203], v211 offset:38912
    v_mfma_f32_16x16x32_bf16 v[164:167], v[8:11], v[56:59], v[164:167]
    ds_read_b128 v[204:207], v211 offset:39936
    v_cvt_pk_bf16_f32 v88, v144, v145
    s_waitcnt lgkmcnt(5)
    v_mfma_f32_16x16x32_bf16 v[168:171], v[12:15], v[40:43], v[168:171]
    ds_read_b64_tr_b16 v[28:29], v237 offset:28672
    v_cvt_pk_bf16_f32 v89, v146, v147
    v_mfma_f32_16x16x32_bf16 v[172:175], v[12:15], v[44:47], v[172:175]
    ds_read_b64_tr_b16 v[30:31], v237 offset:30720
    v_mfma_f32_16x16x32_bf16 v[176:179], v[12:15], v[48:51], v[176:179]
    ds_read_b64_tr_b16 v[32:33], v237 offset:32768
    v_mfma_f32_16x16x32_bf16 v[180:183], v[12:15], v[52:55], v[180:183]
    ds_read_b64_tr_b16 v[34:35], v237 offset:34816
    v_mfma_f32_16x16x32_bf16 v[184:187], v[12:15], v[56:59], v[184:187]
    buffer_store_dwordx2 v[88:89], v232, s[28:31], s41 offen offset:2048 sc1
    s_waitcnt lgkmcnt(2)
    v_mfma_f32_16x16x32_bf16 v[148:151], v[28:31], v[188:191], v[148:151]
    v_mfma_f32_16x16x32_bf16 v[152:155], v[28:31], v[192:195], v[152:155]
    v_mfma_f32_16x16x32_bf16 v[156:159], v[28:31], v[196:199], v[156:159]
    v_mfma_f32_16x16x32_bf16 v[160:163], v[28:31], v[200:203], v[160:163]
    v_mfma_f32_16x16x32_bf16 v[164:167], v[28:31], v[204:207], v[164:167]
    s_waitcnt lgkmcnt(0)
    v_mfma_f32_16x16x32_bf16 v[168:171], v[32:35], v[188:191], v[168:171]
    v_mfma_f32_16x16x32_bf16 v[172:175], v[32:35], v[192:195], v[172:175]
    v_mfma_f32_16x16x32_bf16 v[176:179], v[32:35], v[196:199], v[176:179]
    v_mfma_f32_16x16x32_bf16 v[180:183], v[32:35], v[200:203], v[180:183]
    v_mfma_f32_16x16x32_bf16 v[184:187], v[32:35], v[204:207], v[184:187]
    v_cvt_pk_bf16_f32 v64, v148, v149
    v_cvt_pk_bf16_f32 v65, v150, v151
    v_cvt_pk_bf16_f32 v66, v152, v153
    v_cvt_pk_bf16_f32 v67, v154, v155
    buffer_store_dwordx4 v[64:67], v227, s[28:31], s41 offen offset:3072 sc1
    v_cvt_pk_bf16_f32 v68, v156, v157
    v_cvt_pk_bf16_f32 v69, v158, v159
    v_cvt_pk_bf16_f32 v70, v160, v161
    v_cvt_pk_bf16_f32 v71, v162, v163
    buffer_store_dwordx4 v[68:71], v227, s[28:31], s42 offen offset:0 sc1
    v_cvt_pk_bf16_f32 v72, v164, v165
    v_cvt_pk_bf16_f32 v73, v166, v167
    v_cvt_pk_bf16_f32 v74, v168, v169
    v_cvt_pk_bf16_f32 v75, v170, v171
    buffer_store_dwordx4 v[72:75], v227, s[28:31], s42 offen offset:1024 sc1
    v_cvt_pk_bf16_f32 v76, v172, v173
    v_cvt_pk_bf16_f32 v77, v174, v175
    v_cvt_pk_bf16_f32 v78, v176, v177
    v_cvt_pk_bf16_f32 v79, v178, v179
    buffer_store_dwordx4 v[76:79], v227, s[28:31], s42 offen offset:2048 sc1
    v_cvt_pk_bf16_f32 v80, v180, v181
    v_cvt_pk_bf16_f32 v81, v182, v183
    v_cvt_pk_bf16_f32 v82, v184, v185
    v_cvt_pk_bf16_f32 v83, v186, v187
    buffer_store_dwordx4 v[80:83], v227, s[28:31], s42 offen offset:3072 sc1
    s_waitcnt vmcnt(5)
    s_mov_b64 exec, 3
    buffer_store_dword v231, v235, s[4:7], s40 offen offset:0 sc1
    s_mov_b64 exec, -1
    s_waitcnt vmcnt(1)
    s_mov_b64 exec, 3
    buffer_store_dword v231, v235, s[4:7], s40 offen offset:64 sc1
    s_mov_b64 exec, -1
    s_cmp_lt_u32 s32, 2
    s_cbranch_scc1 L_reduce
    s_branch L_fin
L_helper:
    s_cmp_eq_u32 s47, 8
    s_cbranch_scc1 L_h_2l
    s_lshl_b32 s38, s35, 12
    s_mul_i32 s39, s35, 4224
    s_add_u32 m0, s39, 67584
    s_add_u32 s38, s38, 40960
    buffer_load_dwordx4 v227, s[8:11], s38 offen nt lds
    s_add_u32 m0, m0, 32
    s_nop 0
    buffer_load_dwordx4 v227, s[8:11], s38 offen offset:1024 nt lds
    s_add_u32 m0, m0, 32
    s_nop 0
    buffer_load_dwordx4 v227, s[8:11], s38 offen offset:2048 nt lds
    s_add_u32 m0, m0, 32
    s_nop 0
    buffer_load_dwordx4 v227, s[8:11], s38 offen offset:3072 nt lds
    s_lshl_b32 s38, s35, 12
    s_mul_i32 s39, s35, 4224
    s_add_u32 m0, s39, 84480
    s_add_u32 s38, s38, 32768
    buffer_load_dwordx4 v227, s[12:15], s38 offen nt lds
    s_add_u32 m0, m0, 32
    s_nop 0
    buffer_load_dwordx4 v227, s[12:15], s38 offen offset:1024 nt lds
    s_add_u32 m0, m0, 32
    s_nop 0
    buffer_load_dwordx4 v227, s[12:15], s38 offen offset:2048 nt lds
    s_add_u32 m0, m0, 32
    s_nop 0
    buffer_load_dwordx4 v227, s[12:15], s38 offen offset:3072 nt lds
L_h_2l:
    v_bfe_u32 v230, v216, 2, 2
    v_lshrrev_b32 v231, 4, v216
    v_cmp_eq_u32 vcc, v230, v231
    v_and_b32 v232, 1, v216
    v_lshlrev_b32 v232, 4, v232
    v_mov_b32 v230, 0x3f80
    v_lshlrev_b32 v230, v232, v230
    v_cndmask_b32 v230, 0, v230, vcc
    v_and_b32 v231, 2, v216
    v_cmp_eq_u32 vcc, 0, v231
    v_mov_b32 v138, 0
    v_mov_b32 v139, 0
    v_mov_b32 v140, 0
    v_mov_b32 v141, 0
    v_cndmask_b32 v136, 0, v230, vcc
    v_cndmask_b32 v142, 0, v230, vcc
    v_xor_b32 v137, v136, v230
    v_xor_b32 v143, v136, v230
    s_setprio 1
    s_waitcnt lgkmcnt(0)
    v_mfma_f32_16x16x32_bf16 v[112:115], v[152:155], v[64:67], 0
    v_mfma_f32_16x16x32_bf16 v[112:115], v[156:159], v[68:71], v[112:115]
    v_mfma_f32_16x16x32_bf16 v[112:115], v[160:163], v[72:75], v[112:115]
    v_mfma_f32_16x16x32_bf16 v[112:115], v[164:167], v[76:79], v[112:115]
    v_mfma_f32_16x16x32_bf16 v[120:123], v[152:155], v[80:83], 0
    v_mfma_f32_16x16x32_bf16 v[120:123], v[156:159], v[84:87], v[120:123]
    v_mfma_f32_16x16x32_bf16 v[120:123], v[160:163], v[88:91], v[120:123]
    v_mfma_f32_16x16x32_bf16 v[120:123], v[164:167], v[92:95], v[120:123]
    v_mfma_f32_16x16x32_bf16 v[116:119], v[168:171], v[64:67], 0
    v_mfma_f32_16x16x32_bf16 v[116:119], v[172:175], v[68:71], v[116:119]
    v_mfma_f32_16x16x32_bf16 v[116:119], v[176:179], v[72:75], v[116:119]
    v_mfma_f32_16x16x32_bf16 v[116:119], v[180:183], v[76:79], v[116:119]
    v_mfma_f32_16x16x32_bf16 v[124:127], v[168:171], v[80:83], 0
    v_mfma_f32_16x16x32_bf16 v[124:127], v[172:175], v[84:87], v[124:127]
    v_mfma_f32_16x16x32_bf16 v[124:127], v[176:179], v[88:91], v[124:127]
    v_mfma_f32_16x16x32_bf16 v[124:127], v[180:183], v[92:95], v[124:127]
    s_cmp_lg_u32 s47, 8
    s_cbranch_scc1 L_h_2v
    s_lshl_b32 s38, s35, 12
    s_mul_i32 s39, s35, 4224
    s_add_u32 m0, s39, 67584
    s_add_u32 s38, s38, 40960
    buffer_load_dwordx4 v227, s[8:11], s38 offen nt lds
    s_add_u32 m0, m0, 32
    s_nop 0
    buffer_load_dwordx4 v227, s[8:11], s38 offen offset:1024 nt lds
    s_add_u32 m0, m0, 32
    s_nop 0
    buffer_load_dwordx4 v227, s[8:11], s38 offen offset:2048 nt lds
    s_add_u32 m0, m0, 32
    s_nop 0
    buffer_load_dwordx4 v227, s[8:11], s38 offen offset:3072 nt lds
    s_lshl_b32 s38, s35, 12
    s_mul_i32 s39, s35, 4224
    s_add_u32 m0, s39, 84480
    s_add_u32 s38, s38, 32768
    buffer_load_dwordx4 v227, s[12:15], s38 offen nt lds
    s_add_u32 m0, m0, 32
    s_nop 0
    buffer_load_dwordx4 v227, s[12:15], s38 offen offset:1024 nt lds
    s_add_u32 m0, m0, 32
    s_nop 0
    buffer_load_dwordx4 v227, s[12:15], s38 offen offset:2048 nt lds
    s_add_u32 m0, m0, 32
    s_nop 0
    buffer_load_dwordx4 v227, s[12:15], s38 offen offset:3072 nt lds
L_h_2v:
    s_lshl_b32 s49, s35, 12
    s_add_u32 s49, s49, 49152
    s_mul_i32 s48, s35, 4224
    s_add_u32 s48, s48, 101376
    s_mov_b32 s42, 0
    s_mov_b32 s56, 0
    s_cmp_eq_u32 s47, 8
    s_cselect_b32 s63, 0, 8
    s_and_b32 s38, s33, 3
    s_lshl_b32 s38, s38, 2
    s_lshr_b32 s57, 19592, s38
    s_and_b32 s57, s57, 15
    s_lshr_b32 s38, 44236, s38
    s_and_b32 s38, s38, 15
    s_lshl_b32 s63, -1, s38
    v_max3_f32 v230, v112, v113, v114
    v_max3_f32 v231, v120, v121, v122
    v_max3_f32 v230, v230, v115, v116
    v_max3_f32 v231, v231, v123, v124
    v_max3_f32 v230, v230, v117, v118
    v_max3_f32 v231, v231, v125, v126
    v_max_f32 v230, v230, v119
    v_max_f32 v231, v231, v127
    v_mov_b32 v232, v230
    v_mov_b32 v235, v231
    s_nop 0
    v_permlane16_swap_b32 v230, v232
    v_permlane16_swap_b32 v231, v235
    v_max_f32 v230, v230, v232
    v_max_f32 v231, v231, v235
    v_mov_b32 v232, v230
    v_mov_b32 v235, v231
    s_nop 0
    v_permlane32_swap_b32 v230, v232
    v_permlane32_swap_b32 v231, v235
    v_max_f32 v230, v230, v232
    v_max_f32 v231, v231, v235
    s_cmp_eq_u32 s61, 0
    s_cbranch_scc1 L_fmh
    v_mov_b32 v230, v106
    v_mov_b32 v231, v107
L_fmh:
    v_sub_f32 v96, 0, v230
    v_sub_f32 v97, 0, v230
    v_sub_f32 v98, 0, v230
    v_sub_f32 v99, 0, v230
    v_sub_f32 v100, 0, v231
    v_sub_f32 v101, 0, v231
    v_sub_f32 v102, 0, v231
    v_sub_f32 v103, 0, v231
    v_pk_add_f32 v[112:113], v[112:113], v[96:97]
    v_pk_add_f32 v[114:115], v[114:115], v[96:97]
    v_pk_add_f32 v[116:117], v[116:117], v[96:97]
    v_pk_add_f32 v[118:119], v[118:119], v[96:97]
    v_pk_add_f32 v[120:121], v[120:121], v[100:101]
    v_pk_add_f32 v[122:123], v[122:123], v[100:101]
    v_pk_add_f32 v[124:125], v[124:125], v[100:101]
    v_pk_add_f32 v[126:127], v[126:127], v[100:101]
    s_cmp_lt_u32 s35, 2
    s_cbranch_scc1 L_h_qk
    s_cmp_eq_u32 s35, 2
    s_cbranch_scc1 L_h_pv_end
    v_exp_f32 v112, v112
    v_exp_f32 v113, v113
    v_exp_f32 v114, v114
    v_cvt_pk_bf16_f32 v144, v112, v113
    v_exp_f32 v115, v115
    v_exp_f32 v116, v116
    v_cvt_pk_bf16_f32 v145, v114, v115
    v_exp_f32 v117, v117
    v_exp_f32 v118, v118
    v_cvt_pk_bf16_f32 v146, v116, v117
    v_exp_f32 v119, v119
    v_exp_f32 v120, v120
    v_cvt_pk_bf16_f32 v147, v118, v119
    v_exp_f32 v121, v121
    s_branch L_h_pv
L_h_qk:
    s_sub_u32 s38, s36, 1
    s_cmp_ge_u32 s38, 13
    s_cbranch_scc1 L_h_qk_alt
    v_add_u32 v219, s37, v242
    ds_read_b128 v[152:155], v219 offset:0
    ds_read_b128 v[156:159], v219 offset:64
    ds_read_b128 v[160:163], v219 offset:128
    ds_read_b128 v[164:167], v219 offset:192
    ds_read_b128 v[168:171], v219 offset:512
    ds_read_b128 v[172:175], v219 offset:576
    ds_read_b128 v[176:179], v219 offset:640
    ds_read_b128 v[180:183], v219 offset:704
    s_waitcnt lgkmcnt(4)
    s_setprio 1
    v_mfma_f32_16x16x32_bf16 v[112:115], v[152:155], v[64:67], v[96:99]
    v_mfma_f32_16x16x32_bf16 v[112:115], v[156:159], v[68:71], v[112:115]
    v_mfma_f32_16x16x32_bf16 v[112:115], v[160:163], v[72:75], v[112:115]
    s_add_u32 s38, s49, 8192
    s_and_b32 s39, s38, 0x40000
    v_or_b32 v226, s39, v227
    s_and_b32 s38, s38, 0x3ffff
    s_mov_b32 m0, s48
    v_mfma_f32_16x16x32_bf16 v[112:115], v[164:167], v[76:79], v[112:115]
    s_waitcnt vmcnt(5)
    buffer_load_dwordx4 v226, s[8:11], s38 offen nt lds
    s_add_u32 m0, m0, 32
    s_waitcnt lgkmcnt(0)
    v_mfma_f32_16x16x32_bf16 v[116:119], v[168:171], v[64:67], v[96:99]
    s_waitcnt vmcnt(5)
    buffer_load_dwordx4 v226, s[8:11], s38 offen offset:1024 nt lds
    s_add_u32 m0, m0, 32
    v_mfma_f32_16x16x32_bf16 v[116:119], v[172:175], v[68:71], v[116:119]
    s_waitcnt vmcnt(5)
    buffer_load_dwordx4 v226, s[8:11], s38 offen offset:2048 nt lds
    s_add_u32 m0, m0, 32
    v_mfma_f32_16x16x32_bf16 v[116:119], v[176:179], v[72:75], v[116:119]
    s_waitcnt vmcnt(5)
    buffer_load_dwordx4 v226, s[8:11], s38 offen offset:3072 nt lds
    s_add_u32 m0, s48, 16896
    s_nop 3
    v_exp_f32 v112, v112
    v_mfma_f32_16x16x32_bf16 v[116:119], v[180:183], v[76:79], v[116:119]
    s_waitcnt vmcnt(5)
    buffer_load_dwordx4 v227, s[12:15], s49 offen nt lds
    s_add_u32 m0, m0, 32
    v_exp_f32 v113, v113
    v_mfma_f32_16x16x32_bf16 v[120:123], v[152:155], v[80:83], v[100:103]
    s_waitcnt vmcnt(5)
    buffer_load_dwordx4 v227, s[12:15], s49 offen offset:1024 nt lds
    s_add_u32 m0, m0, 32
    v_exp_f32 v114, v114
    v_cvt_pk_bf16_f32 v144, v112, v113
    v_mfma_f32_16x16x32_bf16 v[120:123], v[156:159], v[84:87], v[120:123]
    v_exp_f32 v115, v115
    v_mfma_f32_16x16x32_bf16 v[120:123], v[160:163], v[88:91], v[120:123]
    v_cvt_pk_bf16_f32 v145, v114, v115
    v_exp_f32 v116, v116
    v_mfma_f32_16x16x32_bf16 v[120:123], v[164:167], v[92:95], v[120:123]
    v_exp_f32 v117, v117
    v_mfma_f32_16x16x32_bf16 v[124:127], v[168:171], v[80:83], v[100:103]
    v_exp_f32 v118, v118
    v_cvt_pk_bf16_f32 v146, v116, v117
    v_mfma_f32_16x16x32_bf16 v[124:127], v[172:175], v[84:87], v[124:127]
    v_exp_f32 v119, v119
    v_mfma_f32_16x16x32_bf16 v[124:127], v[176:179], v[88:91], v[124:127]
    v_cvt_pk_bf16_f32 v147, v118, v119
    v_exp_f32 v120, v120
    v_mfma_f32_16x16x32_bf16 v[124:127], v[180:183], v[92:95], v[124:127]
    v_exp_f32 v121, v121
    s_setprio 0
    s_waitcnt vmcnt(5)
    s_cmp_lt_u32 s36, s57
    s_cbranch_scc1 L_we1
    s_waitcnt vmcnt(3)
    s_bitcmp1_b32 s63, s36
    s_cbranch_scc0 L_we1
    s_waitcnt vmcnt(2)
L_we1:
    buffer_load_dwordx4 v227, s[12:15], s49 offen offset:2048 nt lds
    s_add_u32 m0, m0, 32
    s_waitcnt vmcnt(5)
    s_cmp_lt_u32 s36, s57
    s_cbranch_scc1 L_we2
    s_waitcnt vmcnt(3)
    s_bitcmp1_b32 s63, s36
    s_cbranch_scc0 L_we2
    s_waitcnt vmcnt(2)
L_we2:
    buffer_load_dwordx4 v227, s[12:15], s49 offen offset:3072 nt lds
    s_add_u32 s49, s49, 16384
    s_add_u32 s48, s48, 33792
    s_cmp_ge_u32 s48, 135168
    s_cselect_b32 s39, 135168, 0
    s_sub_u32 s48, s48, s39
L_h_qk_end:
    s_mov_b32 s56, s37
    s_add_u32 s37, s37, 33792
    s_cmp_eq_u32 s37, 135168
    s_cselect_b32 s37, 0, s37
    s_bitcmp1_b32 s35, 0
    s_cselect_b32 s56, s37, s56
    s_add_u32 s36, s36, 1
    s_cmp_eq_u32 s36, 16
    s_waitcnt vmcnt(8) lgkmcnt(0)
    s_barrier
L_h_pv:
    v_add_u32 v220, s56, v244
    v_add_u32 v221, s56, v245
    v_add_u32 v222, s56, v246
    v_add_u32 v223, s56, v247
    ds_read_b64_tr_b16 v[184:185], v220 offset:0
    ds_read_b64_tr_b16 v[186:187], v220 offset:512
    ds_read_b64_tr_b16 v[188:189], v220 offset:32
    ds_read_b64_tr_b16 v[190:191], v220 offset:544
    ds_read_b64_tr_b16 v[192:193], v221 offset:0
    ds_read_b64_tr_b16 v[194:195], v221 offset:512
    ds_read_b64_tr_b16 v[196:197], v221 offset:32
    ds_read_b64_tr_b16 v[198:199], v221 offset:544
    ds_read_b64_tr_b16 v[200:201], v222 offset:0
    ds_read_b64_tr_b16 v[202:203], v222 offset:512
    ds_read_b64_tr_b16 v[204:205], v222 offset:32
    ds_read_b64_tr_b16 v[206:207], v222 offset:544
    ds_read_b64_tr_b16 v[208:209], v223 offset:0
    ds_read_b64_tr_b16 v[210:211], v223 offset:512
    ds_read_b64_tr_b16 v[212:213], v223 offset:32
    ds_read_b64_tr_b16 v[214:215], v223 offset:544
    s_sub_u32 s38, s36, 1
    s_cmp_ge_u32 s38, 13
    s_cbranch_scc1 L_h_pv_alt
    s_waitcnt lgkmcnt(8)
    s_setprio 1
    v_mfma_f32_16x16x32_bf16 v[0:3], v[184:187], v[144:147], v[0:3]
    v_exp_f32 v122, v122
    v_cvt_pk_bf16_f32 v148, v120, v121
    v_mfma_f32_16x16x32_bf16 v[4:7], v[188:191], v[144:147], v[4:7]
    v_exp_f32 v123, v123
    v_mfma_f32_16x16x32_bf16 v[16:19], v[192:195], v[144:147], v[16:19]
    v_exp_f32 v124, v124
    v_cvt_pk_bf16_f32 v149, v122, v123
    s_add_u32 s38, s49, 8192
    s_and_b32 s39, s38, 0x40000
    v_or_b32 v226, s39, v227
    s_and_b32 s38, s38, 0x3ffff
    s_mov_b32 m0, s48
    v_mfma_f32_16x16x32_bf16 v[20:23], v[196:199], v[144:147], v[20:23]
    s_waitcnt vmcnt(5)
    buffer_load_dwordx4 v226, s[8:11], s38 offen nt lds
    s_add_u32 m0, m0, 32
    s_waitcnt lgkmcnt(0)
    v_exp_f32 v125, v125
    v_mfma_f32_16x16x32_bf16 v[32:35], v[200:203], v[144:147], v[32:35]
    s_waitcnt vmcnt(5)
    buffer_load_dwordx4 v226, s[8:11], s38 offen offset:1024 nt lds
    s_add_u32 m0, m0, 32
    v_exp_f32 v126, v126
    v_cvt_pk_bf16_f32 v150, v124, v125
    v_mfma_f32_16x16x32_bf16 v[36:39], v[204:207], v[144:147], v[36:39]
    s_waitcnt vmcnt(5)
    buffer_load_dwordx4 v226, s[8:11], s38 offen offset:2048 nt lds
    s_add_u32 m0, m0, 32
    v_exp_f32 v127, v127
    v_mfma_f32_16x16x32_bf16 v[48:51], v[208:211], v[144:147], v[48:51]
    s_waitcnt vmcnt(5)
    buffer_load_dwordx4 v226, s[8:11], s38 offen offset:3072 nt lds
    s_add_u32 m0, s48, 16896
    v_cvt_pk_bf16_f32 v151, v126, v127
    v_add_f32 v224, v224, v112
    v_mfma_f32_16x16x32_bf16 v[52:55], v[212:215], v[144:147], v[52:55]
    s_waitcnt vmcnt(5)
    buffer_load_dwordx4 v227, s[12:15], s49 offen nt lds
    s_add_u32 m0, m0, 32
    v_add_f32 v225, v225, v113
    v_add_f32 v224, v224, v114
    v_mfma_f32_16x16x32_bf16 v[8:11], v[184:187], v[148:151], v[8:11]
    s_waitcnt vmcnt(5)
    buffer_load_dwordx4 v227, s[12:15], s49 offen offset:1024 nt lds
    s_add_u32 m0, m0, 32
    v_add_f32 v225, v225, v115
    v_add_f32 v224, v224, v116
    v_mfma_f32_16x16x32_bf16 v[12:15], v[188:191], v[148:151], v[12:15]
    v_add_f32 v225, v225, v117
    v_add_f32 v224, v224, v118
    v_mfma_f32_16x16x32_bf16 v[24:27], v[192:195], v[148:151], v[24:27]
    v_add_f32 v225, v225, v119
    v_add_f32 v104, v104, v120
    v_mfma_f32_16x16x32_bf16 v[28:31], v[196:199], v[148:151], v[28:31]
    v_add_f32 v105, v105, v121
    v_add_f32 v104, v104, v122
    v_mfma_f32_16x16x32_bf16 v[40:43], v[200:203], v[148:151], v[40:43]
    v_add_f32 v105, v105, v123
    v_add_f32 v104, v104, v124
    v_mfma_f32_16x16x32_bf16 v[44:47], v[204:207], v[148:151], v[44:47]
    v_add_f32 v105, v105, v125
    v_add_f32 v104, v104, v126
    v_mfma_f32_16x16x32_bf16 v[56:59], v[208:211], v[148:151], v[56:59]
    v_add_f32 v105, v105, v127
    v_mfma_f32_16x16x32_bf16 v[60:63], v[212:215], v[148:151], v[60:63]
    s_setprio 0
    s_waitcnt vmcnt(5)
    s_cmp_lt_u32 s36, s57
    s_cbranch_scc1 L_we3
    s_waitcnt vmcnt(3)
    s_bitcmp1_b32 s63, s36
    s_cbranch_scc0 L_we3
    s_waitcnt vmcnt(2)
L_we3:
    buffer_load_dwordx4 v227, s[12:15], s49 offen offset:2048 nt lds
    s_add_u32 m0, m0, 32
    s_waitcnt vmcnt(5)
    s_cmp_lt_u32 s36, s57
    s_cbranch_scc1 L_we4
    s_waitcnt vmcnt(3)
    s_bitcmp1_b32 s63, s36
    s_cbranch_scc0 L_we4
    s_waitcnt vmcnt(2)
L_we4:
    buffer_load_dwordx4 v227, s[12:15], s49 offen offset:3072 nt lds
    s_add_u32 s49, s49, 16384
    s_add_u32 s48, s48, 33792
    s_cmp_ge_u32 s48, 135168
    s_cselect_b32 s39, 135168, 0
    s_sub_u32 s48, s48, s39
L_h_pv_end:
    s_mov_b32 s56, s37
    s_add_u32 s37, s37, 33792
    s_cmp_eq_u32 s37, 135168
    s_cselect_b32 s37, 0, s37
    s_bitcmp1_b32 s35, 0
    s_cselect_b32 s56, s37, s56
    s_add_u32 s36, s36, 1
    s_cmp_eq_u32 s36, 16
    s_waitcnt vmcnt(8) lgkmcnt(0)
    s_barrier
    s_cbranch_scc0 L_h_qk
    s_branch L_h_tail
L_h_qk_alt:
    s_add_u32 s38, s36, s35
    s_cmp_eq_u32 s38, 18
    s_cbranch_scc1 L_h_last2
    v_add_u32 v219, s37, v242
    ds_read_b128 v[152:155], v219 offset:0
    ds_read_b128 v[156:159], v219 offset:64
    ds_read_b128 v[160:163], v219 offset:128
    ds_read_b128 v[164:167], v219 offset:192
    ds_read_b128 v[168:171], v219 offset:512
    ds_read_b128 v[172:175], v219 offset:576
    ds_read_b128 v[176:179], v219 offset:640
    ds_read_b128 v[180:183], v219 offset:704
    s_waitcnt lgkmcnt(4)
    s_setprio 1
    v_mfma_f32_16x16x32_bf16 v[112:115], v[152:155], v[64:67], v[96:99]
    v_mfma_f32_16x16x32_bf16 v[112:115], v[156:159], v[68:71], v[112:115]
    v_mfma_f32_16x16x32_bf16 v[112:115], v[160:163], v[72:75], v[112:115]
    v_mfma_f32_16x16x32_bf16 v[112:115], v[164:167], v[76:79], v[112:115]
    s_waitcnt lgkmcnt(0)
    v_mfma_f32_16x16x32_bf16 v[116:119], v[168:171], v[64:67], v[96:99]
    v_mfma_f32_16x16x32_bf16 v[116:119], v[172:175], v[68:71], v[116:119]
    v_mfma_f32_16x16x32_bf16 v[116:119], v[176:179], v[72:75], v[116:119]
    s_nop 3
    v_exp_f32 v112, v112
    v_mfma_f32_16x16x32_bf16 v[116:119], v[180:183], v[76:79], v[116:119]
    v_exp_f32 v113, v113
    v_mfma_f32_16x16x32_bf16 v[120:123], v[152:155], v[80:83], v[100:103]
    v_exp_f32 v114, v114
    v_cvt_pk_bf16_f32 v144, v112, v113
    v_mfma_f32_16x16x32_bf16 v[120:123], v[156:159], v[84:87], v[120:123]
    v_exp_f32 v115, v115
    v_mfma_f32_16x16x32_bf16 v[120:123], v[160:163], v[88:91], v[120:123]
    v_cvt_pk_bf16_f32 v145, v114, v115
    v_exp_f32 v116, v116
    v_mfma_f32_16x16x32_bf16 v[120:123], v[164:167], v[92:95], v[120:123]
    v_exp_f32 v117, v117
    v_mfma_f32_16x16x32_bf16 v[124:127], v[168:171], v[80:83], v[100:103]
    v_exp_f32 v118, v118
    v_cvt_pk_bf16_f32 v146, v116, v117
    v_mfma_f32_16x16x32_bf16 v[124:127], v[172:175], v[84:87], v[124:127]
    v_exp_f32 v119, v119
    v_mfma_f32_16x16x32_bf16 v[124:127], v[176:179], v[88:91], v[124:127]
    v_cvt_pk_bf16_f32 v147, v118, v119
    v_exp_f32 v120, v120
    v_mfma_f32_16x16x32_bf16 v[124:127], v[180:183], v[92:95], v[124:127]
    v_exp_f32 v121, v121
    s_setprio 0
    s_cmp_eq_u32 s36, 0
    s_cbranch_scc1 L_h_qk_end
    s_cmp_eq_u32 s36, 15
    s_cbranch_scc1 L_h_last
    s_lshl_b32 s41, s35, 10
    s_add_u32 m0, s41, 0
    s_add_u32 s38, s52, 0
    buffer_load_dwordx4 v228, s[24:27], s38 offen lds
    s_add_u32 m0, s41, 4096
    s_add_u32 s38, s52, 128
    buffer_load_dwordx4 v228, s[24:27], s38 offen lds
    s_add_u32 m0, s41, 8192
    s_add_u32 s38, s52, 256
    buffer_load_dwordx4 v228, s[24:27], s38 offen lds
    s_add_u32 m0, s41, 12288
    s_add_u32 s38, s52, 384
    buffer_load_dwordx4 v228, s[24:27], s38 offen lds
    s_add_u32 m0, s41, 16384
    s_add_u32 s38, s101, 0
    buffer_load_dwordx4 v240, s[24:27], s38 offen lds
    s_add_u32 m0, s41, 20480
    s_add_u32 s38, s52, 36864
    buffer_load_dwordx4 v228, s[24:27], s38 offen lds
    s_add_u32 m0, s41, 24576
    s_add_u32 s38, s52, 36992
    buffer_load_dwordx4 v228, s[24:27], s38 offen lds
    s_add_u32 m0, s41, 28672
    s_add_u32 s38, s52, 37120
    buffer_load_dwordx4 v228, s[24:27], s38 offen lds
    s_branch L_h_qk_end
L_h_last:
    v_add_u32 v220, s37, v244
    v_add_u32 v221, s37, v245
    v_add_u32 v222, s37, v246
    v_add_u32 v223, s37, v247
    ds_read_b64_tr_b16 v[184:185], v220 offset:0
    ds_read_b64_tr_b16 v[186:187], v220 offset:512
    ds_read_b64_tr_b16 v[188:189], v220 offset:32
    ds_read_b64_tr_b16 v[190:191], v220 offset:544
    ds_read_b64_tr_b16 v[192:193], v221 offset:0
    ds_read_b64_tr_b16 v[194:195], v221 offset:512
    ds_read_b64_tr_b16 v[196:197], v221 offset:32
    ds_read_b64_tr_b16 v[198:199], v221 offset:544
    ds_read_b64_tr_b16 v[200:201], v222 offset:0
    ds_read_b64_tr_b16 v[202:203], v222 offset:512
    ds_read_b64_tr_b16 v[204:205], v222 offset:32
    ds_read_b64_tr_b16 v[206:207], v222 offset:544
    ds_read_b64_tr_b16 v[208:209], v223 offset:0
    ds_read_b64_tr_b16 v[210:211], v223 offset:512
    ds_read_b64_tr_b16 v[212:213], v223 offset:32
    ds_read_b64_tr_b16 v[214:215], v223 offset:544
L_h_last2:
    s_lshl_b32 s41, s35, 10
    s_add_u32 m0, s41, 32768
    s_add_u32 s38, s52, 37248
    buffer_load_dwordx4 v228, s[24:27], s38 offen lds
    s_add_u32 m0, s41, 36864
    s_add_u32 s38, s52, 73728
    buffer_load_dwordx4 v228, s[24:27], s38 offen lds
    s_add_u32 m0, s41, 40960
    s_add_u32 s38, s52, 73856
    buffer_load_dwordx4 v228, s[24:27], s38 offen lds
    s_add_u32 m0, s41, 45056
    s_add_u32 s38, s52, 73984
    buffer_load_dwordx4 v228, s[24:27], s38 offen lds
    s_add_u32 m0, s41, 49152
    s_add_u32 s38, s52, 74112
    buffer_load_dwordx4 v228, s[24:27], s38 offen lds
    s_add_u32 m0, s41, 53248
    s_add_u32 s38, s101, 73728
    buffer_load_dwordx4 v240, s[24:27], s38 offen lds
    s_add_u32 m0, s41, 57344
    s_add_u32 s38, s52, 110592
    buffer_load_dwordx4 v228, s[24:27], s38 offen lds
    s_add_u32 m0, s41, 61440
    s_add_u32 s38, s52, 110720
    buffer_load_dwordx4 v228, s[24:27], s38 offen lds
    s_add_u32 m0, s41, 65536
    s_add_u32 s38, s52, 110848
    buffer_load_dwordx4 v228, s[24:27], s38 offen lds
    s_add_u32 m0, s41, 69632
    s_add_u32 s38, s52, 110976
    buffer_load_dwordx4 v228, s[24:27], s38 offen lds
    s_mov_b32 s36, 16
    s_waitcnt lgkmcnt(0)
    s_barrier
    s_cmp_eq_u32 s35, 3
    s_cbranch_scc1 L_h_tail
    s_setprio 1
L_h_pv_alt:
    s_waitcnt lgkmcnt(8)
    s_setprio 1
    v_mfma_f32_16x16x32_bf16 v[0:3], v[184:187], v[144:147], v[0:3]
    v_exp_f32 v122, v122
    v_cvt_pk_bf16_f32 v148, v120, v121
    v_mfma_f32_16x16x32_bf16 v[4:7], v[188:191], v[144:147], v[4:7]
    v_exp_f32 v123, v123
    v_mfma_f32_16x16x32_bf16 v[16:19], v[192:195], v[144:147], v[16:19]
    v_exp_f32 v124, v124
    v_cvt_pk_bf16_f32 v149, v122, v123
    v_mfma_f32_16x16x32_bf16 v[20:23], v[196:199], v[144:147], v[20:23]
    s_waitcnt lgkmcnt(0)
    v_exp_f32 v125, v125
    v_mfma_f32_16x16x32_bf16 v[32:35], v[200:203], v[144:147], v[32:35]
    v_exp_f32 v126, v126
    v_cvt_pk_bf16_f32 v150, v124, v125
    v_mfma_f32_16x16x32_bf16 v[36:39], v[204:207], v[144:147], v[36:39]
    v_exp_f32 v127, v127
    v_mfma_f32_16x16x32_bf16 v[48:51], v[208:211], v[144:147], v[48:51]
    v_cvt_pk_bf16_f32 v151, v126, v127
    v_add_f32 v224, v224, v112
    v_mfma_f32_16x16x32_bf16 v[52:55], v[212:215], v[144:147], v[52:55]
    v_add_f32 v225, v225, v113
    v_add_f32 v224, v224, v114
    v_mfma_f32_16x16x32_bf16 v[8:11], v[184:187], v[148:151], v[8:11]
    v_add_f32 v225, v225, v115
    v_add_f32 v224, v224, v116
    v_mfma_f32_16x16x32_bf16 v[12:15], v[188:191], v[148:151], v[12:15]
    v_add_f32 v225, v225, v117
    v_add_f32 v224, v224, v118
    v_mfma_f32_16x16x32_bf16 v[24:27], v[192:195], v[148:151], v[24:27]
    v_add_f32 v225, v225, v119
    v_add_f32 v104, v104, v120
    v_mfma_f32_16x16x32_bf16 v[28:31], v[196:199], v[148:151], v[28:31]
    v_add_f32 v105, v105, v121
    v_add_f32 v104, v104, v122
    v_mfma_f32_16x16x32_bf16 v[40:43], v[200:203], v[148:151], v[40:43]
    v_add_f32 v105, v105, v123
    v_add_f32 v104, v104, v124
    v_mfma_f32_16x16x32_bf16 v[44:47], v[204:207], v[148:151], v[44:47]
    v_add_f32 v105, v105, v125
    v_add_f32 v104, v104, v126
    v_mfma_f32_16x16x32_bf16 v[56:59], v[208:211], v[148:151], v[56:59]
    v_add_f32 v105, v105, v127
    v_mfma_f32_16x16x32_bf16 v[60:63], v[212:215], v[148:151], v[60:63]
    s_setprio 0
    s_cmp_eq_u32 s36, 0
    s_cbranch_scc1 L_h_pv_end
    s_cmp_eq_u32 s36, 16
    s_cbranch_scc1 L_h_tail
    s_lshl_b32 s41, s35, 10
    s_cmp_eq_u32 s36, 15
    s_cbranch_scc1 L_h_wo15v
    s_add_u32 m0, s41, 0
    s_add_u32 s38, s52, 0
    buffer_load_dwordx4 v228, s[24:27], s38 offen lds
    s_add_u32 m0, s41, 4096
    s_add_u32 s38, s52, 128
    buffer_load_dwordx4 v228, s[24:27], s38 offen lds
    s_add_u32 m0, s41, 8192
    s_add_u32 s38, s52, 256
    buffer_load_dwordx4 v228, s[24:27], s38 offen lds
    s_add_u32 m0, s41, 12288
    s_add_u32 s38, s52, 384
    buffer_load_dwordx4 v228, s[24:27], s38 offen lds
    s_add_u32 m0, s41, 16384
    s_add_u32 s38, s101, 0
    buffer_load_dwordx4 v240, s[24:27], s38 offen lds
    s_add_u32 m0, s41, 20480
    s_add_u32 s38, s52, 36864
    buffer_load_dwordx4 v228, s[24:27], s38 offen lds
    s_add_u32 m0, s41, 24576
    s_add_u32 s38, s52, 36992
    buffer_load_dwordx4 v228, s[24:27], s38 offen lds
    s_add_u32 m0, s41, 28672
    s_add_u32 s38, s52, 37120
    buffer_load_dwordx4 v228, s[24:27], s38 offen lds
    s_branch L_h_pv_end
L_h_wo15v:
    s_add_u32 m0, s41, 32768
    s_add_u32 s38, s52, 37248
    buffer_load_dwordx4 v228, s[24:27], s38 offen lds
    s_add_u32 m0, s41, 36864
    s_add_u32 s38, s52, 73728
    buffer_load_dwordx4 v228, s[24:27], s38 offen lds
    s_add_u32 m0, s41, 40960
    s_add_u32 s38, s52, 73856
    buffer_load_dwordx4 v228, s[24:27], s38 offen lds
    s_add_u32 m0, s41, 45056
    s_add_u32 s38, s52, 73984
    buffer_load_dwordx4 v228, s[24:27], s38 offen lds
    s_add_u32 m0, s41, 49152
    s_add_u32 s38, s52, 74112
    buffer_load_dwordx4 v228, s[24:27], s38 offen lds
    s_add_u32 m0, s41, 53248
    s_add_u32 s38, s101, 73728
    buffer_load_dwordx4 v240, s[24:27], s38 offen lds
    s_add_u32 m0, s41, 57344
    s_add_u32 s38, s52, 110592
    buffer_load_dwordx4 v228, s[24:27], s38 offen lds
    s_add_u32 m0, s41, 61440
    s_add_u32 s38, s52, 110720
    buffer_load_dwordx4 v228, s[24:27], s38 offen lds
    s_add_u32 m0, s41, 65536
    s_add_u32 s38, s52, 110848
    buffer_load_dwordx4 v228, s[24:27], s38 offen lds
    s_add_u32 m0, s41, 69632
    s_add_u32 s38, s52, 110976
    buffer_load_dwordx4 v228, s[24:27], s38 offen lds
    s_branch L_h_pv_end
L_h_tail:
    s_setprio 0
    v_add_f32 v224, v224, v225
    v_add_f32 v225, v104, v105
    s_lshl_b32 s38, s35, 9
    s_add_u32 s38, s38, 141312
    v_lshlrev_b32 v230, 3, v216
    v_add_u32 v231, s38, v230
    ds_write_b64 v231, v[224:225]
    v_add_u32 v230, 141312, v230
    v_add_f32 v235, v224, v225
    v_cmp_nge_f32 vcc, s53, v235
    s_lshl_b32 s38, s32, 2
    s_add_u32 s38, s38, 140288
    v_mov_b32 v234, s38
    s_or_b32 s38, vcc_lo, vcc_hi
    v_mov_b32 v235, s38
    ds_write_b32 v234, v235
    s_xor_b32 s38, s35, 1
    s_lshl_b32 s38, s38, 11
    s_add_u32 s38, s38, 114688
    v_add_u32 v233, s38, v227
    v_cvt_pk_bf16_f32 v152, v16, v17
    v_cvt_pk_bf16_f32 v153, v18, v19
    v_cvt_pk_bf16_f32 v154, v20, v21
    v_cvt_pk_bf16_f32 v155, v22, v23
    v_cvt_pk_bf16_f32 v156, v24, v25
    v_cvt_pk_bf16_f32 v157, v26, v27
    v_cvt_pk_bf16_f32 v158, v28, v29
    v_cvt_pk_bf16_f32 v159, v30, v31
    ds_write_b128 v233, v[152:155] offset:0
    ds_write_b128 v233, v[156:159] offset:1024
    s_xor_b32 s38, s35, 2
    s_lshl_b32 s38, s38, 11
    s_add_u32 s38, s38, 122880
    v_add_u32 v233, s38, v227
    v_cvt_pk_bf16_f32 v160, v32, v33
    v_cvt_pk_bf16_f32 v161, v34, v35
    v_cvt_pk_bf16_f32 v162, v36, v37
    v_cvt_pk_bf16_f32 v163, v38, v39
    v_cvt_pk_bf16_f32 v164, v40, v41
    v_cvt_pk_bf16_f32 v165, v42, v43
    v_cvt_pk_bf16_f32 v166, v44, v45
    v_cvt_pk_bf16_f32 v167, v46, v47
    ds_write_b128 v233, v[160:163] offset:0
    ds_write_b128 v233, v[164:167] offset:1024
    s_xor_b32 s38, s35, 3
    s_lshl_b32 s38, s38, 11
    s_add_u32 s38, s38, 131072
    v_add_u32 v233, s38, v227
    v_cvt_pk_bf16_f32 v168, v48, v49
    v_cvt_pk_bf16_f32 v169, v50, v51
    v_cvt_pk_bf16_f32 v170, v52, v53
    v_cvt_pk_bf16_f32 v171, v54, v55
    v_cvt_pk_bf16_f32 v172, v56, v57
    v_cvt_pk_bf16_f32 v173, v58, v59
    v_cvt_pk_bf16_f32 v174, v60, v61
    v_cvt_pk_bf16_f32 v175, v62, v63
    ds_write_b128 v233, v[168:171] offset:0
    ds_write_b128 v233, v[172:175] offset:1024
    s_lshl_b32 s38, s35, 11
    s_add_u32 s38, s38, 114688
    v_add_u32 v233, s38, v227
    v_subrev_u32 v226, 24576, v241
    s_waitcnt vmcnt(9) lgkmcnt(0)
    s_barrier
    ds_read_b128 v[16:19], v233 offset:0
    ds_read_b128 v[20:23], v233 offset:1024
    ds_read_b128 v[24:27], v233 offset:8192
    ds_read_b128 v[28:31], v233 offset:9216
    ds_read_b128 v[32:35], v233 offset:16384
    ds_read_b128 v[36:39], v233 offset:17408
    ds_read_b64 v[112:113], v230 offset:0
    ds_read_b64 v[114:115], v230 offset:512
    ds_read_b64 v[116:117], v230 offset:1024
    ds_read_b64 v[118:119], v230 offset:1536
    v_mov_b32 v234, 140288
    ds_read_b128 v[128:131], v234
    ds_read_b128 v[132:135], v234 offset:16
    s_waitcnt lgkmcnt(6)
    v_mfma_f32_16x16x32_bf16 v[0:3], v[136:139], v[16:19], v[0:3]
    v_mfma_f32_16x16x32_bf16 v[4:7], v[140:143], v[16:19], v[4:7]
    v_mfma_f32_16x16x32_bf16 v[8:11], v[136:139], v[20:23], v[8:11]
    v_mfma_f32_16x16x32_bf16 v[12:15], v[140:143], v[20:23], v[12:15]
    v_mfma_f32_16x16x32_bf16 v[0:3], v[136:139], v[24:27], v[0:3]
    v_mfma_f32_16x16x32_bf16 v[4:7], v[140:143], v[24:27], v[4:7]
    v_mfma_f32_16x16x32_bf16 v[8:11], v[136:139], v[28:31], v[8:11]
    v_mfma_f32_16x16x32_bf16 v[12:15], v[140:143], v[28:31], v[12:15]
    v_mfma_f32_16x16x32_bf16 v[0:3], v[136:139], v[32:35], v[0:3]
    v_mfma_f32_16x16x32_bf16 v[4:7], v[140:143], v[32:35], v[4:7]
    v_mfma_f32_16x16x32_bf16 v[8:11], v[136:139], v[36:39], v[8:11]
    v_mfma_f32_16x16x32_bf16 v[12:15], v[140:143], v[36:39], v[12:15]
    s_waitcnt lgkmcnt(0)
    v_pk_add_f32 v[112:113], v[112:113], v[114:115]
    v_pk_add_f32 v[116:117], v[116:117], v[118:119]
    v_pk_add_f32 v[112:113], v[112:113], v[116:117]
    v_mov_b32 v114, v112
    v_mov_b32 v115, v113
    s_nop 0
    v_permlane16_swap_b32 v112, v114
    v_permlane16_swap_b32 v113, v115
    v_add_f32 v112, v112, v114
    v_add_f32 v113, v113, v115
    v_mov_b32 v114, v112
    v_mov_b32 v115, v113
    s_nop 0
    v_permlane32_swap_b32 v112, v114
    v_permlane32_swap_b32 v113, v115
    v_add_f32 v112, v112, v114
    v_add_f32 v113, v113, v115
    v_rcp_f32 v230, v112
    v_rcp_f32 v232, v113
    s_nop 0
    v_mov_b32 v231, v230
    v_mov_b32 v233, v232
    v_pk_mul_f32 v[0:1], v[0:1], v[230:231]
    v_pk_mul_f32 v[2:3], v[2:3], v[230:231]
    v_pk_mul_f32 v[4:5], v[4:5], v[230:231]
    v_pk_mul_f32 v[6:7], v[6:7], v[230:231]
    v_pk_mul_f32 v[8:9], v[8:9], v[232:233]
    v_pk_mul_f32 v[10:11], v[10:11], v[232:233]
    v_pk_mul_f32 v[12:13], v[12:13], v[232:233]
    v_pk_mul_f32 v[14:15], v[14:15], v[232:233]
    v_cvt_pk_bf16_f32 v144, v0, v1
    v_cvt_pk_bf16_f32 v145, v2, v3
    v_cvt_pk_bf16_f32 v146, v4, v5
    v_cvt_pk_bf16_f32 v147, v6, v7
    v_cvt_pk_bf16_f32 v148, v8, v9
    v_cvt_pk_bf16_f32 v149, v10, v11
    v_cvt_pk_bf16_f32 v150, v12, v13
    v_cvt_pk_bf16_f32 v151, v14, v15
    ds_write_b128 v241, v[144:147]
    ds_write_b128 v241, v[148:151] offset:20480
    s_movk_i32 s39, 20480
    buffer_store_dwordx4 v[144:147], v226, s[28:31], 0 offen sc1
    buffer_store_dwordx4 v[148:151], v226, s[28:31], s39 offen sc1
    v_or3_b32 v128, v128, v129, v130
    v_or3_b32 v131, v131, v132, v133
    v_or3_b32 v128, v128, v134, v135
    v_or_b32 v128, v128, v131
    s_lshl_b32 s41, s35, 10
    v_readfirstlane_b32 s40, v128
    s_cmp_eq_u32 s61, 0
    s_cselect_b32 s40, s40, 0
    s_cmp_lg_u32 s40, 0
    s_setprio 0
    s_waitcnt lgkmcnt(0)
    s_barrier
    s_cbranch_scc1 L_fallback
    s_lshl_b32 s38, s33, 4
    s_add_u32 s38, s38, s34
    s_xor_b32 s38, s38, 1
    s_mul_i32 s38, s38, 98304
    s_add_u32 s8, s78, s38
    s_addc_u32 s9, s79, 0
    s_mov_b32 s10, 98304
    v_and_b32 v234, 7, v216
    v_lshlrev_b32 v234, 2, v234
    s_lshl_b32 s40, s34, 8
    s_mov_b32 s36, 0
    v_mov_b32 v231, s46
    s_xor_b32 s56, s40, 256
    s_lshl_b32 s38, s32, 2
    s_add_u32 s56, s56, s38
    s_add_u32 m0, s41, 126976
    s_add_u32 s38, s52, 147456
    buffer_load_dwordx4 v228, s[24:27], s38 offen lds
    s_add_u32 m0, s41, 131072
    s_add_u32 s38, s52, 147584
    buffer_load_dwordx4 v228, s[24:27], s38 offen lds
    s_add_u32 m0, s41, 135168
    s_add_u32 s38, s52, 147712
    buffer_load_dwordx4 v228, s[24:27], s38 offen lds
    s_add_u32 m0, s41, 139264
    s_add_u32 s38, s52, 147840
    buffer_load_dwordx4 v228, s[24:27], s38 offen lds
    s_waitcnt vmcnt(6)
    s_barrier
    s_add_u32 m0, s41, 0
    s_add_u32 s38, s52, 221184
    buffer_load_dwordx4 v228, s[24:27], s38 offen lds
    s_add_u32 m0, s41, 4096
    s_add_u32 s38, s52, 221312
    buffer_load_dwordx4 v228, s[24:27], s38 offen lds
    s_add_u32 m0, s41, 8192
    s_add_u32 s38, s52, 221440
    buffer_load_dwordx4 v228, s[24:27], s38 offen lds
    s_waitcnt vmcnt(7)
    s_mov_b64 exec, 1
    buffer_store_dword v231, v234, s[4:7], s56 offen offset:128 sc1
    s_mov_b64 exec, -1
    s_add_u32 m0, s41, 12288
    s_add_u32 s38, s52, 221568
    buffer_load_dwordx4 v228, s[24:27], s38 offen lds
    s_add_u32 m0, s41, 16384
    s_add_u32 s38, s101, 221184
    buffer_load_dwordx4 v240, s[24:27], s38 offen lds
    s_add_u32 m0, s41, 20480
    s_add_u32 s38, s52, 258048
    buffer_load_dwordx4 v228, s[24:27], s38 offen lds
    s_add_u32 m0, s41, 24576
    s_add_u32 s38, s52, 258176
    buffer_load_dwordx4 v228, s[24:27], s38 offen lds
    s_add_u32 m0, s41, 28672
    s_add_u32 s38, s52, 258304
    buffer_load_dwordx4 v228, s[24:27], s38 offen lds
    s_add_u32 m0, s41, 32768
    s_add_u32 s38, s52, 258432
    buffer_load_dwordx4 v228, s[24:27], s38 offen lds
    s_waitcnt vmcnt(10)
    s_barrier
    buffer_load_dword v233, v234, s[4:7], s40 offen offset:128 sc1
    s_add_u32 m0, s41, 36864
    s_add_u32 s38, s100, 0
    buffer_load_dwordx4 v228, s[24:27], s38 offen lds
    s_add_u32 m0, s41, 40960
    s_add_u32 s38, s100, 128
    buffer_load_dwordx4 v228, s[24:27], s38 offen lds
    s_add_u32 m0, s41, 45056
    s_add_u32 s38, s3, 0
    buffer_load_dwordx4 v240, s[24:27], s38 offen lds
    s_add_u32 m0, s41, 49152
    s_add_u32 s38, s100, 36864
    buffer_load_dwordx4 v228, s[24:27], s38 offen lds
    s_add_u32 m0, s41, 53248
    s_add_u32 s38, s100, 36992
    buffer_load_dwordx4 v228, s[24:27], s38 offen lds
    s_add_u32 m0, s41, 57344
    s_add_u32 s38, s100, 73728
    buffer_load_dwordx4 v228, s[24:27], s38 offen lds
    s_add_u32 m0, s41, 61440
    s_add_u32 s38, s100, 73856
    buffer_load_dwordx4 v228, s[24:27], s38 offen lds
    s_add_u32 m0, s41, 65536
    s_add_u32 s38, s3, 73728
    buffer_load_dwordx4 v240, s[24:27], s38 offen lds
    s_add_u32 m0, s41, 69632
    s_add_u32 s38, s100, 110592
    buffer_load_dwordx4 v228, s[24:27], s38 offen lds
    s_waitcnt vmcnt(9)
    v_cmp_ne_u32 vcc, s46, v233
    s_nop 0
    s_cmp_eq_u32 vcc_lo, 0
    s_barrier
    s_cbranch_scc1 L_o_go
L_o_poll:
    buffer_load_dword v233, v234, s[4:7], s40 offen offset:128 sc1
    s_add_u32 s36, s36, 1
    s_waitcnt vmcnt(0)
    v_cmp_ne_u32 vcc, s46, v233
    s_cmp_ge_u32 s36, 0x200000
    s_cbranch_scc1 L_o_go
    s_cmp_eq_u32 vcc_lo, 0
    s_cbranch_scc0 L_o_poll
L_o_go:
    s_add_u32 s38, s41, 0
    s_min_u32 s38, s38, 19456
    s_add_u32 m0, s38, 73728
    s_add_u32 s38, s38, 49152
    buffer_load_dwordx4 v227, s[8:11], s38 offen sc1 lds
    s_add_u32 s38, s41, 4096
    s_min_u32 s38, s38, 19456
    s_add_u32 m0, s38, 73728
    s_add_u32 s38, s38, 49152
    buffer_load_dwordx4 v227, s[8:11], s38 offen sc1 lds
    s_add_u32 s38, s41, 8192
    s_min_u32 s38, s38, 19456
    s_add_u32 m0, s38, 73728
    s_add_u32 s38, s38, 49152
    buffer_load_dwordx4 v227, s[8:11], s38 offen sc1 lds
    s_add_u32 s38, s41, 12288
    s_min_u32 s38, s38, 19456
    s_add_u32 m0, s38, 73728
    s_add_u32 s38, s38, 49152
    buffer_load_dwordx4 v227, s[8:11], s38 offen sc1 lds
    s_add_u32 s38, s41, 16384
    s_min_u32 s38, s38, 19456
    s_add_u32 m0, s38, 73728
    s_add_u32 s38, s38, 49152
    buffer_load_dwordx4 v227, s[8:11], s38 offen sc1 lds
    s_add_u32 s38, s41, 0
    s_min_u32 s38, s38, 9216
    s_add_u32 m0, s38, 94208
    s_add_u32 s38, s38, 69632
    buffer_load_dwordx4 v227, s[8:11], s38 offen sc1 lds
    s_add_u32 s38, s41, 4096
    s_min_u32 s38, s38, 9216
    s_add_u32 m0, s38, 94208
    s_add_u32 s38, s38, 69632
    buffer_load_dwordx4 v227, s[8:11], s38 offen sc1 lds
    s_add_u32 s38, s41, 8192
    s_min_u32 s38, s38, 9216
    s_add_u32 m0, s38, 94208
    s_add_u32 s38, s38, 69632
    buffer_load_dwordx4 v227, s[8:11], s38 offen sc1 lds
    s_add_u32 m0, s41, 126976
    s_add_u32 s38, s100, 110720
    buffer_load_dwordx4 v228, s[24:27], s38 offen lds
    s_add_u32 m0, s41, 131072
    s_add_u32 s38, s100, 147456
    buffer_load_dwordx4 v228, s[24:27], s38 offen lds
    s_waitcnt vmcnt(5)
    s_barrier
    s_add_u32 m0, s41, 135168
    s_add_u32 s38, s100, 147584
    buffer_load_dwordx4 v228, s[24:27], s38 offen lds
    s_add_u32 m0, s41, 139264
    s_add_u32 s38, s3, 147456
    buffer_load_dwordx4 v240, s[24:27], s38 offen lds
    s_add_u32 m0, s41, 143360
    s_add_u32 s38, s100, 184320
    buffer_load_dwordx4 v228, s[24:27], s38 offen lds
    s_add_u32 m0, s41, 147456
    s_add_u32 s38, s100, 184448
    buffer_load_dwordx4 v228, s[24:27], s38 offen lds
    s_add_u32 m0, s41, 151552
    s_add_u32 s38, s100, 221184
    buffer_load_dwordx4 v228, s[24:27], s38 offen lds
    s_add_u32 m0, s41, 155648
    s_add_u32 s38, s100, 221312
    buffer_load_dwordx4 v228, s[24:27], s38 offen lds
    s_add_u32 m0, s41, 159744
    s_add_u32 s38, s3, 221184
    buffer_load_dwordx4 v240, s[24:27], s38 offen lds
    s_add_u32 s38, s41, 0
    s_min_u32 s38, s38, 9216
    s_add_u32 m0, s38, 114688
    s_add_u32 s38, s38, 79872
    buffer_load_dwordx4 v227, s[8:11], s38 offen sc1 lds
    s_add_u32 s38, s41, 4096
    s_min_u32 s38, s38, 9216
    s_add_u32 m0, s38, 114688
    s_add_u32 s38, s38, 79872
    buffer_load_dwordx4 v227, s[8:11], s38 offen sc1 lds
    s_add_u32 s38, s41, 8192
    s_min_u32 s38, s38, 9216
    s_add_u32 m0, s38, 114688
    s_add_u32 s38, s38, 79872
    buffer_load_dwordx4 v227, s[8:11], s38 offen sc1 lds
    s_add_u32 m0, s41, 0
    s_add_u32 s38, s100, 258048
    buffer_load_dwordx4 v228, s[24:27], s38 offen lds
    s_add_u32 m0, s41, 4096
    s_add_u32 s38, s100, 258176
    buffer_load_dwordx4 v228, s[24:27], s38 offen lds
    s_add_u32 m0, s41, 8192
    s_add_u32 s38, s100, 256
    buffer_load_dwordx4 v228, s[24:27], s38 offen lds
    s_waitcnt vmcnt(3)
    s_barrier
    s_add_u32 m0, s41, 12288
    s_add_u32 s38, s100, 384
    buffer_load_dwordx4 v228, s[24:27], s38 offen lds
    s_add_u32 m0, s41, 16384
    s_add_u32 s38, s100, 37120
    buffer_load_dwordx4 v228, s[24:27], s38 offen lds
    s_add_u32 m0, s41, 20480
    s_add_u32 s38, s100, 37248
    buffer_load_dwordx4 v228, s[24:27], s38 offen lds
    s_add_u32 m0, s41, 24576
    s_add_u32 s38, s100, 73984
    buffer_load_dwordx4 v228, s[24:27], s38 offen lds
    s_add_u32 m0, s41, 28672
    s_add_u32 s38, s100, 74112
    buffer_load_dwordx4 v228, s[24:27], s38 offen lds
    s_add_u32 m0, s41, 32768
    s_add_u32 s38, s100, 110848
    buffer_load_dwordx4 v228, s[24:27], s38 offen lds
    s_add_u32 m0, s41, 36864
    s_add_u32 s38, s100, 110976
    buffer_load_dwordx4 v228, s[24:27], s38 offen lds
    s_add_u32 m0, s41, 40960
    s_add_u32 s38, s100, 147712
    buffer_load_dwordx4 v228, s[24:27], s38 offen lds
    s_add_u32 m0, s41, 45056
    s_add_u32 s38, s100, 147840
    buffer_load_dwordx4 v228, s[24:27], s38 offen lds
    s_add_u32 m0, s41, 49152
    s_add_u32 s38, s100, 184576
    buffer_load_dwordx4 v228, s[24:27], s38 offen lds
    s_add_u32 m0, s41, 53248
    s_add_u32 s38, s100, 184704
    buffer_load_dwordx4 v228, s[24:27], s38 offen lds
    s_add_u32 m0, s41, 57344
    s_add_u32 s38, s100, 221440
    buffer_load_dwordx4 v228, s[24:27], s38 offen lds
    s_add_u32 m0, s41, 61440
    s_add_u32 s38, s100, 221568
    buffer_load_dwordx4 v228, s[24:27], s38 offen lds
    s_add_u32 m0, s41, 65536
    s_add_u32 s38, s100, 258304
    buffer_load_dwordx4 v228, s[24:27], s38 offen lds
    s_add_u32 m0, s41, 69632
    s_add_u32 s38, s100, 258432
    buffer_load_dwordx4 v228, s[24:27], s38 offen lds
    s_waitcnt vmcnt(9)
    s_barrier
    s_waitcnt vmcnt(0)
    s_barrier
L_reduce:
    s_bfe_u32 s38, s34, 0x10001
    s_lshl_b32 s39, s38, 2
    s_add_u32 s39, s39, s35
    s_cmp_eq_u32 s39, 7
    s_cselect_b32 s39, 11, s39
    s_lshl_b32 s38, s38, 1
    s_add_u32 s38, s38, s35
    s_add_u32 s38, s38, 7
    s_cmp_ge_u32 s32, 4
    s_cselect_b32 s47, s39, s38
    s_lshr_b32 s56, s34, 2
    s_lshr_b32 s38, s56, 1
    s_lshl_b32 s38, s38, 4
    s_add_u32 s38, s38, s47
    s_cmp_eq_u32 s38, 22
    s_cbranch_scc1 L_fin
    v_and_b32 v234, 7, v216
    v_lshlrev_b32 v234, 2, v234
    s_lshl_b32 s41, s34, 8
    s_cmp_ge_u32 s47, 7
    s_cselect_b32 s38, 64, 0
    s_add_u32 s41, s41, s38
    buffer_load_dword v233, v234, s[4:7], s41 offen sc1
    s_mul_i32 s38, s33, 92160
    s_add_u32 s16, s74, s38
    s_addc_u32 s17, s75, 0
    s_mul_i32 s38, s33, 1572864
    s_add_u32 s20, s78, s38
    s_addc_u32 s21, s79, 0
    s_mov_b32 s22, 1572864
    s_mov_b32 s36, 0
    s_mov_b32 s62, 0
    s_lshl_b32 s38, s47, 1
    s_add_u32 s38, s38, 0
    s_min_u32 s39, s38, 12
    s_add_u32 s38, s38, 1
    s_cmp_ge_u32 s47, 7
    s_cselect_b32 s38, s38, s39
    s_mul_i32 s39, s38, 52
    s_lshr_b32 s39, s39, 8
    s_mul_i32 s40, s39, 5
    s_sub_u32 s38, s38, s40
    s_cmp_ge_u32 s56, 2
    s_cselect_b32 s40, 3, 0
    s_add_u32 s38, s38, s40
    s_cmp_ge_u32 s38, 5
    s_cselect_b32 s40, 5, 0
    s_sub_u32 s38, s38, s40
    s_mul_i32 s58, s38, 18432
    s_and_b32 s38, s34, 1
    s_cmp_ge_u32 s39, 3
    s_cselect_b32 s40, 1, 0
    s_sub_u32 s40, s39, s40
    s_lshl_b32 s40, s40, 2
    s_add_u32 s40, s40, s56
    s_mul_i32 s42, s38, 20
    s_add_u32 s40, s40, s42
    s_lshl_b32 s38, s38, 1
    s_and_b32 s42, s56, 1
    s_add_u32 s38, s38, s42
    s_add_u32 s38, s38, 16
    s_cmp_eq_u32 s39, 2
    s_cselect_b32 s40, s38, s40
    s_lshl_b32 s40, s40, 5
    s_add_u32 s58, s58, s40
    s_lshl_b32 s38, s47, 1
    s_add_u32 s38, s38, 1
    s_min_u32 s39, s38, 12
    s_add_u32 s38, s38, 1
    s_cmp_ge_u32 s47, 7
    s_cselect_b32 s38, s38, s39
    s_mul_i32 s39, s38, 52
    s_lshr_b32 s39, s39, 8
    s_mul_i32 s40, s39, 5
    s_sub_u32 s38, s38, s40
    s_cmp_ge_u32 s56, 2
    s_cselect_b32 s40, 3, 0
    s_add_u32 s38, s38, s40
    s_cmp_ge_u32 s38, 5
    s_cselect_b32 s40, 5, 0
    s_sub_u32 s38, s38, s40
    s_mul_i32 s59, s38, 18432
    s_and_b32 s38, s34, 1
    s_cmp_ge_u32 s39, 3
    s_cselect_b32 s40, 1, 0
    s_sub_u32 s40, s39, s40
    s_lshl_b32 s40, s40, 2
    s_add_u32 s40, s40, s56
    s_mul_i32 s42, s38, 20
    s_add_u32 s40, s40, s42
    s_lshl_b32 s38, s38, 1
    s_and_b32 s42, s56, 1
    s_add_u32 s38, s38, s42
    s_add_u32 s38, s38, 16
    s_cmp_eq_u32 s39, 2
    s_cselect_b32 s40, s38, s40
    s_lshl_b32 s40, s40, 5
    s_add_u32 s59, s59, s40
    s_cmp_eq_u32 s47, 6
    s_cselect_b32 s38, 1, 0
    v_lshlrev_b32 v230, s38, v216
    v_and_b32 v235, 64, v230
    v_lshlrev_b32 v235, 24, v235
    v_or_b32 v80, v227, v235
    v_and_b32 v231, 15, v230
    v_mul_u32_u24 v231, 1152, v231
    v_bfe_u32 v232, v230, 4, 2
    v_lshl_add_u32 v231, v232, 3, v231
    v_or_b32 v81, v231, v235
    s_mul_i32 s38, s38, 1152
    v_add_u32 v82, s38, v81
    v_bfe_u32 v230, v216, 2, 2
    v_lshrrev_b32 v231, 4, v216
    v_cmp_eq_u32 vcc, v230, v231
    v_and_b32 v232, 1, v216
    v_lshlrev_b32 v232, 4, v232
    v_mov_b32 v230, 0x3f80
    v_lshlrev_b32 v230, v232, v230
    v_cndmask_b32 v230, 0, v230, vcc
    v_and_b32 v231, 2, v216
    v_cmp_eq_u32 vcc, 0, v231
    v_mov_b32 v86, 0
    v_mov_b32 v87, 0
    v_mov_b32 v88, 0
    v_mov_b32 v89, 0
    v_cndmask_b32 v84, 0, v230, vcc
    v_cndmask_b32 v90, 0, v230, vcc
    v_xor_b32 v85, v84, v230
    v_xor_b32 v91, v84, v230
    s_mul_i32 s39, s56, 12288
    s_lshl_b32 s38, s47, 10
    s_add_u32 s39, s39, s38
    s_and_b32 s38, s34, 1
    s_mul_i32 s38, s38, 98304
    s_add_u32 s39, s39, s38
    s_branch L_r_chk
L_r_poll:
    buffer_load_dword v233, v234, s[4:7], s41 offen sc1
L_r_chk:
    s_add_u32 s36, s36, 1
    s_waitcnt vmcnt(0)
    v_cmp_eq_u32 vcc, s46, v233
    s_cmp_ge_u32 s36, 0x200000
    s_cbranch_scc1 L_r_done
    s_andn2_b32 s38, vcc_lo, s62
    s_and_b32 s38, s38, 0xff
    s_cbranch_scc1 L_r_new
    s_sleep 2
    s_branch L_r_poll
L_r_new:
    s_or_b32 s62, s62, s38
    s_bitcmp1_b32 s38, 0
    s_cbranch_scc0 L_r_n0
    s_add_u32 s42, s39, 0
    buffer_load_dwordx4 v[8:11], v80, s[20:23], s42 offen sc1
L_r_n0:
    s_bitcmp1_b32 s38, 1
    s_cbranch_scc0 L_r_n1
    s_add_u32 s42, s39, 196608
    buffer_load_dwordx4 v[12:15], v80, s[20:23], s42 offen sc1
L_r_n1:
    s_bitcmp1_b32 s38, 2
    s_cbranch_scc0 L_r_n2
    s_add_u32 s42, s39, 393216
    buffer_load_dwordx4 v[16:19], v80, s[20:23], s42 offen sc1
L_r_n2:
    s_bitcmp1_b32 s38, 3
    s_cbranch_scc0 L_r_n3
    s_add_u32 s42, s39, 589824
    buffer_load_dwordx4 v[20:23], v80, s[20:23], s42 offen sc1
L_r_n3:
    s_bitcmp1_b32 s38, 4
    s_cbranch_scc0 L_r_n4
    s_add_u32 s42, s39, 786432
    buffer_load_dwordx4 v[24:27], v80, s[20:23], s42 offen sc1
L_r_n4:
    s_bitcmp1_b32 s38, 5
    s_cbranch_scc0 L_r_n5
    s_add_u32 s42, s39, 983040
    buffer_load_dwordx4 v[28:31], v80, s[20:23], s42 offen sc1
L_r_n5:
    s_bitcmp1_b32 s38, 6
    s_cbranch_scc0 L_r_n6
    s_add_u32 s42, s39, 1179648
    buffer_load_dwordx4 v[32:35], v80, s[20:23], s42 offen sc1
L_r_n6:
    s_bitcmp1_b32 s38, 7
    s_cbranch_scc0 L_r_n7
    s_add_u32 s42, s39, 1376256
    buffer_load_dwordx4 v[36:39], v80, s[20:23], s42 offen sc1
L_r_n7:
    s_cmp_lg_u32 s62, 0xff
    s_cbranch_scc1 L_r_poll
L_r_done:
    s_waitcnt vmcnt(0)
    v_mfma_f32_16x16x32_bf16 v[72:75], v[84:87], v[8:11], 0
    v_mfma_f32_16x16x32_bf16 v[72:75], v[84:87], v[12:15], v[72:75]
    v_mfma_f32_16x16x32_bf16 v[72:75], v[84:87], v[16:19], v[72:75]
    v_mfma_f32_16x16x32_bf16 v[72:75], v[84:87], v[20:23], v[72:75]
    v_mfma_f32_16x16x32_bf16 v[72:75], v[84:87], v[24:27], v[72:75]
    v_mfma_f32_16x16x32_bf16 v[72:75], v[84:87], v[28:31], v[72:75]
    v_mfma_f32_16x16x32_bf16 v[72:75], v[84:87], v[32:35], v[72:75]
    v_mfma_f32_16x16x32_bf16 v[72:75], v[84:87], v[36:39], v[72:75]
    v_mfma_f32_16x16x32_bf16 v[76:79], v[88:91], v[8:11], 0
    v_mfma_f32_16x16x32_bf16 v[76:79], v[88:91], v[12:15], v[76:79]
    v_mfma_f32_16x16x32_bf16 v[76:79], v[88:91], v[16:19], v[76:79]
    v_mfma_f32_16x16x32_bf16 v[76:79], v[88:91], v[20:23], v[76:79]
    v_mfma_f32_16x16x32_bf16 v[76:79], v[88:91], v[24:27], v[76:79]
    v_mfma_f32_16x16x32_bf16 v[76:79], v[88:91], v[28:31], v[76:79]
    v_mfma_f32_16x16x32_bf16 v[76:79], v[88:91], v[32:35], v[76:79]
    v_mfma_f32_16x16x32_bf16 v[76:79], v[88:91], v[36:39], v[76:79]
    v_cvt_pk_bf16_f32 v0, v72, v73
    v_cvt_pk_bf16_f32 v1, v74, v75
    buffer_store_dwordx2 v[0:1], v81, s[16:19], s58 offen
    s_nop 4
    v_cvt_pk_bf16_f32 v2, v76, v77
    v_cvt_pk_bf16_f32 v3, v78, v79
    buffer_store_dwordx2 v[2:3], v82, s[16:19], s59 offen
    s_lshl_b32 s38, s34, 3
    s_add_u32 s38, s38, s32
    s_cmp_lg_u32 s38, 4
    s_cbranch_scc1 L_fin
    s_lshl_b32 s38, s33, 7
    s_add_u32 s38, s38, 33619968
    v_mov_b32 v4, s38
    v_mov_b32 v5, s46
    s_mov_b64 exec, 1
    global_store_dword v4, v5, s[78:79] sc1
    s_mov_b64 exec, -1
L_fin:
    s_barrier
    s_cmp_lg_u32 s32, 3
    s_cbranch_scc1 L_fin2
    s_xor_b32 s38, s46, 2
    v_mov_b32 v5, s38
    v_lshlrev_b32 v4, 2, v216
    s_lshl_b32 s38, s34, 8
    buffer_store_dword v5, v4, s[4:7], s38 offen sc1
L_fin2:
L_end:
    s_endpgm
L_code_end:
L_fallback:
    s_waitcnt vmcnt(0) lgkmcnt(0)
    s_barrier
    s_mov_b32 s61, 1
    s_mov_b32 s36, 0
    v_mov_b32 v106, 0xff800000
    v_mov_b32 v107, 0xff800000
    v_mov_b32 v219, v217
L_fb_loop:
    s_cmp_lt_u32 s32, 4
    s_cbranch_scc1 L_fb_nold
    s_lshl_b32 s38, s35, 12
    s_lshl_b32 s39, s36, 14
    s_add_u32 s38, s38, s39
    s_mul_i32 m0, s35, 4224
    s_nop 0
    buffer_load_dwordx4 v227, s[8:11], s38 offen lds
    s_add_u32 m0, m0, 32
    s_nop 0
    buffer_load_dwordx4 v227, s[8:11], s38 offen offset:1024 lds
    s_add_u32 m0, m0, 32
    s_nop 0
    buffer_load_dwordx4 v227, s[8:11], s38 offen offset:2048 lds
    s_add_u32 m0, m0, 32
    s_nop 0
    buffer_load_dwordx4 v227, s[8:11], s38 offen offset:3072 lds
L_fb_nold:
    s_waitcnt vmcnt(0)
    s_barrier
    ds_read_b128 v[152:155], v219 offset:0
    ds_read_b128 v[156:159], v219 offset:64
    ds_read_b128 v[160:163], v219 offset:128
    ds_read_b128 v[164:167], v219 offset:192
    ds_read_b128 v[168:171], v219 offset:512
    ds_read_b128 v[172:175], v219 offset:576
    ds_read_b128 v[176:179], v219 offset:640
    ds_read_b128 v[180:183], v219 offset:704
    s_waitcnt lgkmcnt(0)
    v_mfma_f32_16x16x32_bf16 v[112:115], v[152:155], v[64:67], 0
    v_mfma_f32_16x16x32_bf16 v[112:115], v[156:159], v[68:71], v[112:115]
    v_mfma_f32_16x16x32_bf16 v[112:115], v[160:163], v[72:75], v[112:115]
    v_mfma_f32_16x16x32_bf16 v[112:115], v[164:167], v[76:79], v[112:115]
    v_mfma_f32_16x16x32_bf16 v[120:123], v[152:155], v[80:83], 0
    v_mfma_f32_16x16x32_bf16 v[120:123], v[156:159], v[84:87], v[120:123]
    v_mfma_f32_16x16x32_bf16 v[120:123], v[160:163], v[88:91], v[120:123]
    v_mfma_f32_16x16x32_bf16 v[120:123], v[164:167], v[92:95], v[120:123]
    v_mfma_f32_16x16x32_bf16 v[116:119], v[168:171], v[64:67], 0
    v_mfma_f32_16x16x32_bf16 v[116:119], v[172:175], v[68:71], v[116:119]
    v_mfma_f32_16x16x32_bf16 v[116:119], v[176:179], v[72:75], v[116:119]
    v_mfma_f32_16x16x32_bf16 v[116:119], v[180:183], v[76:79], v[116:119]
    v_mfma_f32_16x16x32_bf16 v[124:127], v[168:171], v[80:83], 0
    v_mfma_f32_16x16x32_bf16 v[124:127], v[172:175], v[84:87], v[124:127]
    v_mfma_f32_16x16x32_bf16 v[124:127], v[176:179], v[88:91], v[124:127]
    v_mfma_f32_16x16x32_bf16 v[124:127], v[180:183], v[92:95], v[124:127]
    s_nop 7
    v_max3_f32 v230, v112, v113, v114
    v_max3_f32 v231, v120, v121, v122
    v_max3_f32 v230, v230, v115, v116
    v_max3_f32 v231, v231, v123, v124
    v_max3_f32 v230, v230, v117, v118
    v_max3_f32 v231, v231, v125, v126
    v_max_f32 v230, v230, v119
    v_max_f32 v231, v231, v127
    v_max_f32 v106, v106, v230
    v_max_f32 v107, v107, v231
    ds_read_b128 v[152:155], v219 offset:8448
    ds_read_b128 v[156:159], v219 offset:8512
    ds_read_b128 v[160:163], v219 offset:8576
    ds_read_b128 v[164:167], v219 offset:8640
    ds_read_b128 v[168:171], v219 offset:8960
    ds_read_b128 v[172:175], v219 offset:9024
    ds_read_b128 v[176:179], v219 offset:9088
    ds_read_b128 v[180:183], v219 offset:9152
    s_waitcnt lgkmcnt(0)
    v_mfma_f32_16x16x32_bf16 v[112:115], v[152:155], v[64:67], 0
    v_mfma_f32_16x16x32_bf16 v[112:115], v[156:159], v[68:71], v[112:115]
    v_mfma_f32_16x16x32_bf16 v[112:115], v[160:163], v[72:75], v[112:115]
    v_mfma_f32_16x16x32_bf16 v[112:115], v[164:167], v[76:79], v[112:115]
    v_mfma_f32_16x16x32_bf16 v[120:123], v[152:155], v[80:83], 0
    v_mfma_f32_16x16x32_bf16 v[120:123], v[156:159], v[84:87], v[120:123]
    v_mfma_f32_16x16x32_bf16 v[120:123], v[160:163], v[88:91], v[120:123]
    v_mfma_f32_16x16x32_bf16 v[120:123], v[164:167], v[92:95], v[120:123]
    v_mfma_f32_16x16x32_bf16 v[116:119], v[168:171], v[64:67], 0
    v_mfma_f32_16x16x32_bf16 v[116:119], v[172:175], v[68:71], v[116:119]
    v_mfma_f32_16x16x32_bf16 v[116:119], v[176:179], v[72:75], v[116:119]
    v_mfma_f32_16x16x32_bf16 v[116:119], v[180:183], v[76:79], v[116:119]
    v_mfma_f32_16x16x32_bf16 v[124:127], v[168:171], v[80:83], 0
    v_mfma_f32_16x16x32_bf16 v[124:127], v[172:175], v[84:87], v[124:127]
    v_mfma_f32_16x16x32_bf16 v[124:127], v[176:179], v[88:91], v[124:127]
    v_mfma_f32_16x16x32_bf16 v[124:127], v[180:183], v[92:95], v[124:127]
    s_nop 7
    v_max3_f32 v230, v112, v113, v114
    v_max3_f32 v231, v120, v121, v122
    v_max3_f32 v230, v230, v115, v116
    v_max3_f32 v231, v231, v123, v124
    v_max3_f32 v230, v230, v117, v118
    v_max3_f32 v231, v231, v125, v126
    v_max_f32 v230, v230, v119
    v_max_f32 v231, v231, v127
    v_max_f32 v106, v106, v230
    v_max_f32 v107, v107, v231
    s_barrier
    s_add_u32 s36, s36, 1
    s_cmp_lt_u32 s36, 16
    s_cbranch_scc1 L_fb_loop
    v_mov_b32 v230, v106
    v_mov_b32 v231, v107
    s_nop 0
    v_permlane16_swap_b32 v106, v230
    v_permlane16_swap_b32 v107, v231
    v_max_f32 v106, v106, v230
    v_max_f32 v107, v107, v231
    v_mov_b32 v230, v106
    v_mov_b32 v231, v107
    s_nop 0
    v_permlane32_swap_b32 v106, v230
    v_permlane32_swap_b32 v107, v231
    v_max_f32 v106, v106, v230
    v_max_f32 v107, v107, v231
    v_mov_b32 v0, 0
    v_mov_b32 v1, 0
    v_mov_b32 v2, 0
    v_mov_b32 v3, 0
    v_mov_b32 v4, 0
    v_mov_b32 v5, 0
    v_mov_b32 v6, 0
    v_mov_b32 v7, 0
    v_mov_b32 v8, 0
    v_mov_b32 v9, 0
    v_mov_b32 v10, 0
    v_mov_b32 v11, 0
    v_mov_b32 v12, 0
    v_mov_b32 v13, 0
    v_mov_b32 v14, 0
    v_mov_b32 v15, 0
    v_mov_b32 v16, 0
    v_mov_b32 v17, 0
    v_mov_b32 v18, 0
    v_mov_b32 v19, 0
    v_mov_b32 v20, 0
    v_mov_b32 v21, 0
    v_mov_b32 v22, 0
    v_mov_b32 v23, 0
    v_mov_b32 v24, 0
    v_mov_b32 v25, 0
    v_mov_b32 v26, 0
    v_mov_b32 v27, 0
    v_mov_b32 v28, 0
    v_mov_b32 v29, 0
    v_mov_b32 v30, 0
    v_mov_b32 v31, 0
    v_mov_b32 v32, 0
    v_mov_b32 v33, 0
    v_mov_b32 v34, 0
    v_mov_b32 v35, 0
    v_mov_b32 v36, 0
    v_mov_b32 v37, 0
    v_mov_b32 v38, 0
    v_mov_b32 v39, 0
    v_mov_b32 v40, 0
    v_mov_b32 v41, 0
    v_mov_b32 v42, 0
    v_mov_b32 v43, 0
    v_mov_b32 v44, 0
    v_mov_b32 v45, 0
    v_mov_b32 v46, 0
    v_mov_b32 v47, 0
    v_mov_b32 v48, 0
    v_mov_b32 v49, 0
    v_mov_b32 v50, 0
    v_mov_b32 v51, 0
    v_mov_b32 v52, 0
    v_mov_b32 v53, 0
    v_mov_b32 v54, 0
    v_mov_b32 v55, 0
    v_mov_b32 v56, 0
    v_mov_b32 v57, 0
    v_mov_b32 v58, 0
    v_mov_b32 v59, 0
    v_mov_b32 v60, 0
    v_mov_b32 v61, 0
    v_mov_b32 v62, 0
    v_mov_b32 v63, 0
    v_mov_b32 v224, 0
    v_mov_b32 v225, 0
    v_mov_b32 v104, 0
    v_mov_b32 v105, 0
    v_add_u32 v219, 155392, v217
    s_mov_b32 s47, 100
    s_add_u32 m0, s60, 155392
    s_add_u32 s38, s44, 0
    buffer_load_dwordx4 v227, s[8:11], s38 offen nt lds
    s_add_u32 m0, s60, 0
    s_add_u32 s38, s44, 8192
    buffer_load_dwordx4 v227, s[8:11], s38 offen nt lds
    s_add_u32 m0, s60, 16896
    s_add_u32 s38, s44, 0
    buffer_load_dwordx4 v227, s[12:15], s38 offen nt lds
    s_add_u32 m0, s60, 8448
    s_add_u32 s38, s44, 16384
    buffer_load_dwordx4 v227, s[8:11], s38 offen nt lds
    s_add_u32 m0, s60, 25344
    s_add_u32 s38, s44, 8192
    buffer_load_dwordx4 v227, s[12:15], s38 offen nt lds
    s_add_u32 m0, s60, 33792
    s_add_u32 s38, s44, 24576
    buffer_load_dwordx4 v227, s[8:11], s38 offen nt lds
    s_add_u32 m0, s60, 50688
    s_add_u32 s38, s44, 16384
    buffer_load_dwordx4 v227, s[12:15], s38 offen nt lds
    s_add_u32 m0, s60, 42240
    s_add_u32 s38, s44, 32768
    buffer_load_dwordx4 v227, s[8:11], s38 offen nt lds
    s_add_u32 m0, s60, 59136
    s_add_u32 s38, s44, 24576
    buffer_load_dwordx4 v227, s[12:15], s38 offen nt lds
    s_add_u32 m0, s60, 67584
    s_add_u32 s38, s44, 40960
    buffer_load_dwordx4 v227, s[8:11], s38 offen nt lds
    s_add_u32 m0, s60, 76032
    s_add_u32 s38, s44, 49152
    buffer_load_dwordx4 v227, s[8:11], s38 offen nt lds
    s_waitcnt vmcnt(0)
    s_barrier
    s_branch L_restart
.section .rodata,"a"
.p2align 6
.amdhsa_kernel standalone__gqa_block_cached__near_ridge_kernel
.amdhsa_next_free_vgpr 256
.amdhsa_next_free_sgpr 102
.amdhsa_accum_offset 256
.amdhsa_group_segment_fixed_size 0
.amdhsa_kernarg_size 64
.amdhsa_user_sgpr_count 2
.amdhsa_user_sgpr_kernarg_segment_ptr 1
.amdhsa_system_sgpr_workgroup_id_x 1
.end_amdhsa_kernel
```
